```python
import torch

def _softmax(x, axis=-1):
    return torch.softmax(x, dim=axis)
def _gelu(x):
    return torch.nn.functional.gelu(x, approximate="tanh")
def _silu(x):
    return torch.nn.functional.silu(x)
def _sigmoid(x):
    return torch.sigmoid(x)
def _layernorm(x, axis=-1, eps=1e-5):
    m = x.mean(dim=axis, keepdim=True)
    v = x.var(dim=axis, keepdim=True, unbiased=False)
    return (x - m) / torch.sqrt(v + eps)
def _scatter_add(tgt, idx, src, axis=0):
    return tgt.clone().index_add_(axis, idx, src)
def _segment_sum(src, seg, n):
    out = torch.zeros((n,) + src.shape[1:], dtype=src.dtype)
    return out.index_add_(0, seg, src)
def _pad(x, pw):
    flat = tuple(v for pair in reversed(pw) for v in pair)
    return torch.nn.functional.pad(x, flat)

kernel_name = 'concat_heads__linear_attn_block__softmax_full_mha__prompt'

def setup_inputs():

    _w = (lambda a: (lambda t: t.to(torch.bfloat16) if t.is_floating_point() else t)(torch.as_tensor(a)))
    def _A_setup():
        B, S, D = 1, 2048, 1024
        return {
            "x": _w((lambda *s: torch.randn(*s, dtype=torch.bfloat16) * 0.05)(B, S, D)),
            "wqkv": _w((lambda *s: torch.randn(*s, dtype=torch.bfloat16) * 1.6)(D, 3 * D)),
            "wo": _w((lambda *s: torch.randn(*s, dtype=torch.bfloat16) * 0.1)(D, D)),
        }
    _A_in = _A_setup()

    def _B_setup():
        B, S, D = 1, 2048, 1024
        return {
            "x": _w((lambda *s: torch.randn(*s, dtype=torch.bfloat16) * 0.2)(B, S, D)),
            "wqkv": _w((lambda *s: torch.randn(*s, dtype=torch.bfloat16) * 0.2)(D, 3 * D)),
            "wo": _w((lambda *s: torch.randn(*s, dtype=torch.bfloat16) * 0.05)(D, D)),
        }
    _B_in = _B_setup()

    return {
        "A_x": _A_in["x"],
        "A_wqkv": _A_in["wqkv"],
        "A_wo": _A_in["wo"],
        "B_x": _B_in["x"],
        "B_wqkv": _B_in["wqkv"],
        "B_wo": _B_in["wo"],
    }

def reference(A_x, A_wqkv, A_wo, B_x, B_wqkv, B_wo):
    def _A_ref(x, wqkv, wo):
        B, S, D = x.shape
        H = 32; Dh = D // H
        qkv = (lambda x, *d: x.permute(*d))((x @ wqkv).reshape(B, S, 3, H, Dh), 2, 0, 3, 1, 4)
        q, k, v = qkv[0], qkv[1], qkv[2]
        phi = lambda t: torch.where(t > 0, t + 1, torch.exp(t)) + 1e-6
        pq, pk = phi(q), phi(k)
        kv = torch.einsum("bhsd,bhse->bhde", pk, v)
        z = torch.einsum("bhsd->bhd", pk)
        num = torch.einsum("bhqd,bhde->bhqe", pq, kv)
        den = torch.einsum("bhqd,bhd->bhq", pq, z)[..., None] + 1e-6
        o = num / den
        return (lambda x, *d: x.permute(*d))(o, 0, 2, 1, 3).reshape(B, S, D) @ wo

    def _B_ref(x, wqkv, wo):
        B, S, D = x.shape
        H = 32; Dh = D // H
        qkv = (lambda x, *d: x.permute(*d))((x @ wqkv).reshape(B, S, 3, H, Dh), 2, 0, 3, 1, 4)
        q, k, v = qkv[0], qkv[1], qkv[2]
        scale = Dh ** -0.5
        scores = torch.einsum("bhqd,bhkd->bhqk", q, k) * scale
        p = _softmax(scores, axis=-1)
        o = torch.einsum("bhqk,bhkd->bhqd", p, v)
        return (lambda x, *d: x.permute(*d))(o, 0, 2, 1, 3).reshape(B, S, D) @ wo

    a = _A_ref(A_x, A_wqkv, A_wo)
    b = _B_ref(B_x, B_wqkv, B_wo)
    return torch.concatenate([a, b], axis=-1)
```

```asm
; @launch kernel=concat_heads__linear_attn_block__softmax_full_mha__prompt_kernel grid=(256,1,1) block=(512,1,1) lds=159744
.amdgcn_target "amdgcn-amd-amdhsa--gfx950"
.text
.globl concat_heads__linear_attn_block__softmax_full_mha__prompt_kernel
.p2align 8
.type concat_heads__linear_attn_block__softmax_full_mha__prompt_kernel,@function
concat_heads__linear_attn_block__softmax_full_mha__prompt_kernel:
    s_cmp_ge_u32 s2, 256
    s_cbranch_scc1 L_at_end
    s_load_dwordx4 s[4:7], s[0:1], 0
    s_load_dwordx4 s[48:51], s[0:1], 24
    s_load_dwordx2 s[8:9], s[0:1], 64
    v_lshrrev_b32 v188, 6, v0
    s_and_b32 s39, s2, 7
    s_lshr_b32 s40, s2, 3
    v_readfirstlane_b32 s27, v188
    s_lshr_b32 s24, s40, 4
    s_and_b32 s25, s39, 1
    s_lshl_b32 s25, s25, 2
    s_and_b32 s41, s40, 3
    s_add_u32 s25, s25, s41
    s_lshr_b32 s26, s39, 1
    s_lshl_b32 s26, s26, 2
    s_lshr_b32 s41, s40, 2
    s_and_b32 s41, s41, 3
    s_add_u32 s26, s26, s41
    v_and_b32 v188, 63, v0
    v_lshlrev_b32 v187, 4, v188
    v_lshrrev_b32 v189, 3, v188
    v_lshlrev_b32 v189, 11, v189
    v_lshrrev_b32 v190, 4, v188
    v_and_b32 v191, 7, v188
    v_xor_b32 v191, v191, v190
    v_lshlrev_b32 v191, 4, v191
    v_add_u32 v189, v189, v191
    s_lshl_b32 s39, s27, 16
    v_add_u32 v180, s39, v189
    v_xor_b32 v181, 64, v180
    v_add_u32 v181, 15360, v181
    v_add_u32 v182, 30720, v180
    v_add_u32 v183, 30720, v181
    v_lshrrev_b32 v189, 3, v188
    s_and_b32 s39, s27, 3
    s_lshl_b32 s40, s39, 3
    v_add_u32 v189, s40, v189
    v_mul_u32_u24 v189, 6144, v189
    v_and_b32 v190, 1, v190
    v_lshlrev_b32 v190, 2, v190
    v_and_b32 v191, 7, v188
    v_xor_b32 v191, v191, v190
    s_and_b32 s40, s27, 1
    s_lshl_b32 s40, s40, 1
    v_xor_b32 v191, s40, v191
    v_lshlrev_b32 v191, 4, v191
    v_add_u32 v184, v189, v191
    v_add_u32 v185, 1024, v184
    v_add_u32 v186, 2048, v184
    s_mul_i32 s38, s39, 3072
    s_add_u32 s38, s38, 98304
    s_lshl_b32 s37, s27, 12
    s_lshl_b32 s28, s25, 19
    s_lshl_b32 s29, s26, 7
    s_lshr_b32 s40, s27, 2
    s_mul_i32 s41, s40, 196608
    s_add_u32 s29, s29, s41
    s_mul_i32 s41, s40, 12288
    s_add_u32 s31, s38, s41
    s_mov_b32 s30, s37
    s_waitcnt lgkmcnt(0)
    s_cmp_eq_u32 s24, 0
    s_cselect_b32 s4, s4, s48
    s_cselect_b32 s5, s5, s49
    s_cselect_b32 s6, s6, s50
    s_cselect_b32 s7, s7, s51
    s_mov_b32 s12, s4
    s_and_b32 s13, s5, 0xffff
    s_mov_b32 s14, 4194304
    s_mov_b32 s15, 0x00020000
    s_mov_b32 s16, s6
    s_and_b32 s17, s7, 0xffff
    s_mov_b32 s18, 6291456
    s_mov_b32 s19, 0x00020000
    s_cmp_ge_u32 s27, 4
    s_cbranch_scc1 L_qkv_pro1
    s_mov_b32 m0, s31
    s_nop 0
    buffer_load_dwordx4 v184, s[16:19], s29 offen offset:0 lds
    buffer_load_dwordx4 v185, s[16:19], s29 offen offset:1024 lds
    buffer_load_dwordx4 v186, s[16:19], s29 offen offset:2048 lds
    s_add_u32 s29, s29, 393216
    s_add_u32 s31, s31, 24576
    s_sub_u32 s39, s31, 61440
    s_cmp_ge_u32 s31, 159744
    s_cselect_b32 s31, s39, s31
    s_mov_b32 m0, s30
    s_nop 0
    buffer_load_dwordx4 v180, s[12:15], s28 offen offset:0 lds
    buffer_load_dwordx4 v181, s[12:15], s28 offen offset:1024 lds
    buffer_load_dwordx4 v182, s[12:15], s28 offen offset:2048 lds
    buffer_load_dwordx4 v183, s[12:15], s28 offen offset:3072 lds
    s_add_u32 s28, s28, 128
    s_add_u32 s30, s30, 32768
    s_cmp_ge_u32 s30, 98304
    s_cselect_b32 s30, s37, s30
    s_branch L_qkv_pro2
L_qkv_pro1:
    s_mov_b32 m0, s30
    s_nop 0
    buffer_load_dwordx4 v180, s[12:15], s28 offen offset:0 lds
    buffer_load_dwordx4 v181, s[12:15], s28 offen offset:1024 lds
    buffer_load_dwordx4 v182, s[12:15], s28 offen offset:2048 lds
    buffer_load_dwordx4 v183, s[12:15], s28 offen offset:3072 lds
    s_add_u32 s28, s28, 128
    s_add_u32 s30, s30, 32768
    s_cmp_ge_u32 s30, 98304
    s_cselect_b32 s30, s37, s30
    s_mov_b32 m0, s31
    s_nop 0
    buffer_load_dwordx4 v184, s[16:19], s29 offen offset:0 lds
    buffer_load_dwordx4 v185, s[16:19], s29 offen offset:1024 lds
    buffer_load_dwordx4 v186, s[16:19], s29 offen offset:2048 lds
    s_add_u32 s29, s29, 393216
    s_add_u32 s31, s31, 24576
    s_sub_u32 s39, s31, 61440
    s_cmp_ge_u32 s31, 159744
    s_cselect_b32 s31, s39, s31
L_qkv_pro2:
    s_mov_b32 s20, s8
    s_and_b32 s21, s9, 0xffff
    s_mov_b32 s22, 33554432
    s_mov_b32 s23, 0x00020000
    s_mov_b32 s84, 26869760
    s_lshl_b32 s83, s24, 4
    s_add_u32 s83, s83, s26
    s_lshl_b32 s83, s83, 3
    s_add_u32 s83, s83, s25
    s_lshl_b32 s83, s83, 7
    s_add_u32 s83, s83, 26804224
    s_getpc_b64 s[56:57]
L_qkv_pc:
    s_lshr_b32 s39, s2, 3
    s_lshl_b32 s39, s39, 3
    s_add_u32 s39, s39, s27
    s_lshl_b32 s39, s39, 6
    s_min_u32 s39, s39, L_at_fallback-L_qkv_epi_1-4
    s_add_u32 s39, s39, L_qkv_epi_1-L_qkv_pc
    s_add_u32 s56, s56, s39
    s_addc_u32 s57, s57, 0
    s_lshl_b32 s39, s26, 3
    s_add_u32 s39, s39, s25
    s_lshl_b32 s39, s39, 3
    s_add_u32 s39, s39, s27
    s_lshl_b32 s39, s39, 10
    s_lshr_b32 s40, s6, 7
    s_sub_u32 s40, 3, s40
    s_and_b32 s40, s40, 7
    s_lshl_b32 s40, s40, 7
    s_add_u32 s46, s39, s40
    s_lshr_b32 s40, s4, 7
    s_sub_u32 s40, 3, s40
    s_and_b32 s40, s40, 7
    s_lshl_b32 s40, s40, 7
    s_add_u32 s47, s39, s40
    v_lshlrev_b32 v200, 20, v188
    v_and_b32 v189, 15, v188
    v_lshrrev_b32 v190, 1, v189
    v_lshrrev_b32 v191, 4, v188
    v_xor_b32 v190, v190, v191
    v_lshlrev_b32 v190, 4, v190
    v_lshlrev_b32 v176, 7, v189
    v_add_u32 v176, v176, v190
    s_lshr_b32 s39, s27, 1
    s_lshl_b32 s39, s39, 13
    v_add_u32 v176, s39, v176
    v_xor_b32 v177, 64, v176
    v_mul_u32_u24 v178, 3072, v191
    v_lshrrev_b32 v190, 2, v189
    v_lshlrev_b32 v190, 7, v190
    v_add_u32 v178, v178, v190
    v_lshrrev_b32 v190, 3, v189
    s_and_b32 s39, s27, 1
    v_xor_b32 v190, s39, v190
    v_lshlrev_b32 v190, 6, v190
    v_add_u32 v178, v178, v190
    v_and_b32 v190, 1, v191
    v_lshlrev_b32 v190, 5, v190
    v_add_u32 v178, v178, v190
    v_and_b32 v190, 3, v188
    v_lshlrev_b32 v190, 3, v190
    v_add_u32 v178, v178, v190
    v_add_u32 v178, 98304, v178
    v_xor_b32 v179, 32, v178
    v_lshlrev_b32 v192, 9, v191
    v_lshlrev_b32 v190, 4, v189
    v_and_b32 v193, 0x70, v190
    v_add_u32 v193, v193, v192
    v_add_u32 v192, v192, v190
    v_and_b32 v190, 0x80, v190
    v_lshlrev_b32 v190, 1, v190
    v_add_u32 v193, v193, v190
    v_mov_b32 v196, 0x358637bd
    v_mov_b32 v197, 0x358637bd
    v_mov_b32 v198, 0x358637bd
    v_mov_b32 v199, 0x358637bd
    s_mov_b32 s32, 1
    s_mov_b32 s35, 1
    s_mov_b32 s36, 2
    s_mov_b32 s52, 12288
    s_mov_b32 s53, 32768
    s_and_b32 s39, s27, 1
    s_lshl_b32 s40, s26, 1
    s_add_u32 s39, s39, s40
    s_and_b32 s40, s27, 6
    s_lshl_b32 s41, s25, 3
    s_add_u32 s40, s40, s41
    s_lshl_b32 s42, s39, 17
    s_lshl_b32 s41, s40, 11
    s_add_u32 s42, s42, s41
    s_cmp_eq_u32 s24, 0
    s_cbranch_scc1 L_qkv_sca
    s_lshl_b32 s43, s42, 1
    s_add_u32 s43, s43, 4194304
    s_add_u32 s54, s43, 4096
    s_mov_b32 s44, 0x3e8293ee
    s_mov_b32 s45, 0x3e8293ee
    s_cmp_ge_u32 s27, 4
    s_cbranch_scc1 L_qkv_ent_1_1
    s_branch L_qkv_ent_1_0
L_qkv_sca:
    s_add_u32 s42, s42, 12582912
    s_lshl_b32 s43, s39, 15
    s_lshl_b32 s41, s25, 12
    s_add_u32 s43, s43, s41
    s_lshr_b32 s54, s43, 5
    s_add_u32 s54, s54, 26214400
    s_lshr_b32 s41, s27, 1
    s_lshl_b32 s41, s41, 10
    s_add_u32 s43, s43, s41
    s_add_u32 s43, s43, 25165824
    s_mov_b32 s44, 0x3fb8aa3b
    s_mov_b32 s45, 0x3fb8aa3b
    s_mov_b32 s55, 0x358637bd
    v_mov_b32 v194, 0xb5c1a2a0
    v_mov_b32 v195, 0xb5c1a2a0
    s_cmp_ge_u32 s27, 4
    s_cbranch_scc1 L_qkv_ent_0_1
L_qkv_ent_0_0:
    s_barrier
    s_mov_b32 m0, s30
    s_nop 0
    buffer_load_dwordx4 v180, s[12:15], s28 offen offset:0 lds
    buffer_load_dwordx4 v181, s[12:15], s28 offen offset:1024 lds
    buffer_load_dwordx4 v182, s[12:15], s28 offen offset:2048 lds
    buffer_load_dwordx4 v183, s[12:15], s28 offen offset:3072 lds
    s_add_u32 s28, s28, 128
    s_add_u32 s30, s30, 32768
    s_cmp_ge_u32 s30, 98304
    s_cselect_b32 s30, s37, s30
    s_waitcnt vmcnt(4)
    s_barrier
    ds_read_b64_tr_b16 v[112:113], v178 offset:0
    ds_read_b64_tr_b16 v[114:115], v178 offset:512
    ds_read_b128 v[96:99], v176 offset:0
    ds_read_b128 v[100:103], v176 offset:2048
    ds_read_b128 v[104:107], v176 offset:4096
    ds_read_b128 v[108:111], v176 offset:6144
    ds_read_b64_tr_b16 v[116:117], v179 offset:0
    ds_read_b64_tr_b16 v[118:119], v179 offset:512
    ds_read_b64_tr_b16 v[120:121], v178 offset:1024
    ds_read_b64_tr_b16 v[122:123], v178 offset:1536
    ds_read_b64_tr_b16 v[124:125], v179 offset:1024
    ds_read_b64_tr_b16 v[126:127], v179 offset:1536
    ds_read_b64_tr_b16 v[128:129], v178 offset:2048
    ds_read_b64_tr_b16 v[130:131], v178 offset:2560
    s_mov_b32 m0, s31
    s_nop 0
    buffer_load_dwordx4 v184, s[16:19], s29 offen offset:0 lds
    s_waitcnt lgkmcnt(8)
    ds_read_b64_tr_b16 v[132:133], v179 offset:2048
    ds_read_b64_tr_b16 v[134:135], v179 offset:2560
    v_mfma_f32_16x16x32_bf16 v[0:3], v[112:115], v[96:99], v[196:199]
    buffer_load_dwordx4 v185, s[16:19], s29 offen offset:1024 lds
    v_mfma_f32_16x16x32_bf16 v[24:27], v[112:115], v[100:103], v[196:199]
    v_mfma_f32_16x16x32_bf16 v[48:51], v[112:115], v[104:107], v[196:199]
    v_mfma_f32_16x16x32_bf16 v[72:75], v[112:115], v[108:111], v[196:199]
    s_waitcnt lgkmcnt(0)
    buffer_load_dwordx4 v186, s[16:19], s29 offen offset:2048 lds
    v_mfma_f32_16x16x32_bf16 v[76:79], v[116:119], v[108:111], v[196:199]
    ds_read_b64_tr_b16 v[152:153], v178 offset:12288
    v_mfma_f32_16x16x32_bf16 v[52:55], v[116:119], v[104:107], v[196:199]
    ds_read_b64_tr_b16 v[154:155], v178 offset:12800
    v_mfma_f32_16x16x32_bf16 v[28:31], v[116:119], v[100:103], v[196:199]
    ds_read_b128 v[136:139], v177 offset:0
    s_add_u32 s29, s29, 393216
    s_add_u32 s31, s31, 24576
    s_sub_u32 s39, s31, 61440
    s_cmp_ge_u32 s31, 159744
    s_cselect_b32 s31, s39, s31
    s_mov_b32 m0, s31
    s_nop 0
    buffer_load_dwordx4 v184, s[16:19], s29 offen offset:0 lds
    v_mfma_f32_16x16x32_bf16 v[4:7], v[116:119], v[96:99], v[196:199]
    ds_read_b128 v[140:143], v177 offset:2048
    v_mfma_f32_16x16x32_bf16 v[8:11], v[96:99], v[120:123], v[196:199]
    ds_read_b128 v[144:147], v177 offset:4096
    v_mfma_f32_16x16x32_bf16 v[32:35], v[100:103], v[120:123], v[196:199]
    ds_read_b128 v[148:151], v177 offset:6144
    buffer_load_dwordx4 v185, s[16:19], s29 offen offset:1024 lds
    v_mfma_f32_16x16x32_bf16 v[56:59], v[104:107], v[120:123], v[196:199]
    ds_read_b64_tr_b16 v[156:157], v179 offset:12288
    v_mfma_f32_16x16x32_bf16 v[80:83], v[108:111], v[120:123], v[196:199]
    ds_read_b64_tr_b16 v[158:159], v179 offset:12800
    v_mfma_f32_16x16x32_bf16 v[84:87], v[108:111], v[124:127], v[196:199]
    ds_read_b64_tr_b16 v[160:161], v178 offset:13312
    buffer_load_dwordx4 v186, s[16:19], s29 offen offset:2048 lds
    v_mfma_f32_16x16x32_bf16 v[60:63], v[104:107], v[124:127], v[196:199]
    ds_read_b64_tr_b16 v[162:163], v178 offset:13824
    v_mfma_f32_16x16x32_bf16 v[36:39], v[100:103], v[124:127], v[196:199]
    ds_read_b64_tr_b16 v[164:165], v179 offset:13312
    v_mfma_f32_16x16x32_bf16 v[12:15], v[96:99], v[124:127], v[196:199]
    ds_read_b64_tr_b16 v[166:167], v179 offset:13824
    s_add_u32 s29, s29, 393216
    s_add_u32 s31, s31, 24576
    s_sub_u32 s39, s31, 61440
    s_cmp_ge_u32 s31, 159744
    s_cselect_b32 s31, s39, s31
    buffer_load_dword v201, v200, s[16:19], s46 offen
    v_mfma_f32_16x16x32_bf16 v[16:19], v[96:99], v[128:131], 0
    ds_read_b64_tr_b16 v[168:169], v178 offset:14336
    v_mfma_f32_16x16x32_bf16 v[40:43], v[100:103], v[128:131], 0
    ds_read_b64_tr_b16 v[170:171], v178 offset:14848
    v_mfma_f32_16x16x32_bf16 v[64:67], v[104:107], v[128:131], 0
    ds_read_b64_tr_b16 v[172:173], v179 offset:14336
    buffer_load_dword v202, v200, s[12:15], s47 offen
    v_mfma_f32_16x16x32_bf16 v[88:91], v[108:111], v[128:131], 0
    ds_read_b64_tr_b16 v[174:175], v179 offset:14848
    v_mfma_f32_16x16x32_bf16 v[92:95], v[108:111], v[132:135], 0
    v_mfma_f32_16x16x32_bf16 v[68:71], v[104:107], v[132:135], 0
    v_mfma_f32_16x16x32_bf16 v[44:47], v[100:103], v[132:135], 0
    v_add_u32 v178, 24576, v178
    v_add_u32 v179, 24576, v179
    v_add_u32 v176, 32768, v176
    v_add_u32 v177, 32768, v177
    v_mfma_f32_16x16x32_bf16 v[20:23], v[96:99], v[132:135], 0
    s_waitcnt vmcnt(3) lgkmcnt(0)
    s_branch L_qkv_in_0_0
.p2align 6
L_qkv_loop_0_0:
    v_mfma_f32_16x16x32_bf16 v[92:95], v[108:111], v[132:135], v[92:95]
    v_mfma_f32_16x16x32_bf16 v[68:71], v[104:107], v[132:135], v[68:71]
    s_waitcnt vmcnt(3) lgkmcnt(0)
    v_mfma_f32_16x16x32_bf16 v[44:47], v[100:103], v[132:135], v[44:47]
    v_mfma_f32_16x16x32_bf16 v[20:23], v[96:99], v[132:135], v[20:23]
L_qkv_in_0_0:
    s_barrier
    v_mfma_f32_16x16x32_bf16 v[0:3], v[152:155], v[136:139], v[0:3]
    ds_read_b64_tr_b16 v[112:113], v178 offset:0
    s_cmp_eq_u32 s32, 11
    s_cbranch_scc1 L_qkv_cp_0_0
L_qkv_cpr_0_0:
    v_mfma_f32_16x16x32_bf16 v[24:27], v[152:155], v[140:143], v[24:27]
    ds_read_b64_tr_b16 v[114:115], v178 offset:512
    s_mov_b32 m0, s30
    v_mfma_f32_16x16x32_bf16 v[48:51], v[152:155], v[144:147], v[48:51]
    ds_read_b128 v[96:99], v176 offset:0
    buffer_load_dwordx4 v180, s[12:15], s28 offen offset:0 lds
    v_mfma_f32_16x16x32_bf16 v[72:75], v[152:155], v[148:151], v[72:75]
    ds_read_b128 v[100:103], v176 offset:2048
    v_mfma_f32_16x16x32_bf16 v[76:79], v[156:159], v[148:151], v[76:79]
    ds_read_b128 v[104:107], v176 offset:4096
    v_mfma_f32_16x16x32_bf16 v[52:55], v[156:159], v[144:147], v[52:55]
    ds_read_b128 v[108:111], v176 offset:6144
    buffer_load_dwordx4 v181, s[12:15], s28 offen offset:1024 lds
    v_mfma_f32_16x16x32_bf16 v[28:31], v[156:159], v[140:143], v[28:31]
    ds_read_b64_tr_b16 v[116:117], v179 offset:0
    v_mfma_f32_16x16x32_bf16 v[4:7], v[156:159], v[136:139], v[4:7]
    ds_read_b64_tr_b16 v[118:119], v179 offset:512
    v_mfma_f32_16x16x32_bf16 v[8:11], v[136:139], v[160:163], v[8:11]
    ds_read_b64_tr_b16 v[120:121], v178 offset:1024
    buffer_load_dwordx4 v182, s[12:15], s28 offen offset:2048 lds
    v_mfma_f32_16x16x32_bf16 v[32:35], v[140:143], v[160:163], v[32:35]
    ds_read_b64_tr_b16 v[122:123], v178 offset:1536
    v_mfma_f32_16x16x32_bf16 v[56:59], v[144:147], v[160:163], v[56:59]
    ds_read_b64_tr_b16 v[124:125], v179 offset:1024
    v_mfma_f32_16x16x32_bf16 v[80:83], v[148:151], v[160:163], v[80:83]
    ds_read_b64_tr_b16 v[126:127], v179 offset:1536
    buffer_load_dwordx4 v183, s[12:15], s28 offen offset:3072 lds
    v_mfma_f32_16x16x32_bf16 v[84:87], v[148:151], v[164:167], v[84:87]
    ds_read_b64_tr_b16 v[128:129], v178 offset:2048
    s_add_u32 s28, s28, 128
    v_mfma_f32_16x16x32_bf16 v[60:63], v[144:147], v[164:167], v[60:63]
    ds_read_b64_tr_b16 v[130:131], v178 offset:2560
    s_add_u32 s30, s30, 32768
    v_mfma_f32_16x16x32_bf16 v[36:39], v[140:143], v[164:167], v[36:39]
    ds_read_b64_tr_b16 v[132:133], v179 offset:2048
    s_cmp_ge_u32 s30, 98304
    v_mfma_f32_16x16x32_bf16 v[12:15], v[136:139], v[164:167], v[12:15]
    ds_read_b64_tr_b16 v[134:135], v179 offset:2560
    s_cselect_b32 s30, s37, s30
    v_mfma_f32_16x16x32_bf16 v[16:19], v[136:139], v[168:171], v[16:19]
    s_add_u32 s36, s36, 1
    s_cmp_eq_u32 s36, 5
    v_mfma_f32_16x16x32_bf16 v[40:43], v[140:143], v[168:171], v[40:43]
    s_cselect_b32 s36, 0, s36
    v_mfma_f32_16x16x32_bf16 v[64:67], v[144:147], v[168:171], v[64:67]
    s_cselect_b32 s34, 4294918144, s52
    v_add_u32 v178, s34, v178
    v_mfma_f32_16x16x32_bf16 v[88:91], v[148:151], v[168:171], v[88:91]
    v_add_u32 v179, s34, v179
    v_mfma_f32_16x16x32_bf16 v[92:95], v[148:151], v[172:175], v[92:95]
    v_mfma_f32_16x16x32_bf16 v[68:71], v[144:147], v[172:175], v[68:71]
    s_waitcnt lgkmcnt(0)
    v_mfma_f32_16x16x32_bf16 v[44:47], v[140:143], v[172:175], v[44:47]
    v_mfma_f32_16x16x32_bf16 v[20:23], v[136:139], v[172:175], v[20:23]
    s_barrier
    v_mfma_f32_16x16x32_bf16 v[0:3], v[112:115], v[96:99], v[0:3]
    ds_read_b64_tr_b16 v[152:153], v178 offset:0
    v_mfma_f32_16x16x32_bf16 v[24:27], v[112:115], v[100:103], v[24:27]
    ds_read_b64_tr_b16 v[154:155], v178 offset:512
    s_mov_b32 m0, s31
    v_mfma_f32_16x16x32_bf16 v[48:51], v[112:115], v[104:107], v[48:51]
    ds_read_b128 v[136:139], v177 offset:0
    buffer_load_dwordx4 v184, s[16:19], s29 offen offset:0 lds
    v_mfma_f32_16x16x32_bf16 v[72:75], v[112:115], v[108:111], v[72:75]
    ds_read_b128 v[140:143], v177 offset:2048
    v_mfma_f32_16x16x32_bf16 v[76:79], v[116:119], v[108:111], v[76:79]
    ds_read_b128 v[144:147], v177 offset:4096
    v_mfma_f32_16x16x32_bf16 v[52:55], v[116:119], v[104:107], v[52:55]
    ds_read_b128 v[148:151], v177 offset:6144
    buffer_load_dwordx4 v185, s[16:19], s29 offen offset:1024 lds
    v_mfma_f32_16x16x32_bf16 v[28:31], v[116:119], v[100:103], v[28:31]
    ds_read_b64_tr_b16 v[156:157], v179 offset:0
    v_mfma_f32_16x16x32_bf16 v[4:7], v[116:119], v[96:99], v[4:7]
    ds_read_b64_tr_b16 v[158:159], v179 offset:512
    v_mfma_f32_16x16x32_bf16 v[8:11], v[96:99], v[120:123], v[8:11]
    ds_read_b64_tr_b16 v[160:161], v178 offset:1024
    buffer_load_dwordx4 v186, s[16:19], s29 offen offset:2048 lds
    v_mfma_f32_16x16x32_bf16 v[32:35], v[100:103], v[120:123], v[32:35]
    ds_read_b64_tr_b16 v[162:163], v178 offset:1536
    v_mfma_f32_16x16x32_bf16 v[56:59], v[104:107], v[120:123], v[56:59]
    ds_read_b64_tr_b16 v[164:165], v179 offset:1024
    v_mfma_f32_16x16x32_bf16 v[80:83], v[108:111], v[120:123], v[80:83]
    ds_read_b64_tr_b16 v[166:167], v179 offset:1536
    v_mfma_f32_16x16x32_bf16 v[84:87], v[108:111], v[124:127], v[84:87]
    ds_read_b64_tr_b16 v[168:169], v178 offset:2048
    s_add_u32 s29, s29, 393216
    s_add_u32 s31, s31, 24576
    v_mfma_f32_16x16x32_bf16 v[60:63], v[104:107], v[124:127], v[60:63]
    ds_read_b64_tr_b16 v[170:171], v178 offset:2560
    s_sub_u32 s39, s31, 61440
    v_mfma_f32_16x16x32_bf16 v[36:39], v[100:103], v[124:127], v[36:39]
    ds_read_b64_tr_b16 v[172:173], v179 offset:2048
    s_cmp_ge_u32 s31, 159744
    v_mfma_f32_16x16x32_bf16 v[12:15], v[96:99], v[124:127], v[12:15]
    ds_read_b64_tr_b16 v[174:175], v179 offset:2560
    s_cselect_b32 s31, s39, s31
    v_mfma_f32_16x16x32_bf16 v[16:19], v[96:99], v[128:131], v[16:19]
    s_add_u32 s36, s36, 1
    s_cmp_eq_u32 s36, 5
    s_cselect_b32 s36, 0, s36
    s_cselect_b32 s34, 4294918144, s52
    v_mfma_f32_16x16x32_bf16 v[40:43], v[100:103], v[128:131], v[40:43]
    v_add_u32 v178, s34, v178
    v_add_u32 v179, s34, v179
    s_add_u32 s35, s35, 1
    v_mfma_f32_16x16x32_bf16 v[64:67], v[104:107], v[128:131], v[64:67]
    s_cmp_eq_u32 s35, 3
    s_cselect_b32 s35, 0, s35
    s_cselect_b32 s33, 4294901760, s53
    v_add_u32 v176, s33, v176
    v_mfma_f32_16x16x32_bf16 v[88:91], v[108:111], v[128:131], v[88:91]
    v_add_u32 v177, s33, v177
    s_add_u32 s32, s32, 1
    s_cmp_lt_u32 s32, 14
    s_cbranch_scc1 L_qkv_loop_0_0
    s_branch L_qkv_epi_0
L_qkv_cp_0_0:
    s_load_dword s58, s[56:57], 0
    buffer_load_dword v203, off, s[20:23], s84 sc1
    s_branch L_qkv_cpr_0_0
L_qkv_ent_0_1:
    s_barrier
    s_mov_b32 m0, s30
    s_nop 0
    buffer_load_dwordx4 v180, s[12:15], s28 offen offset:0 lds
    buffer_load_dwordx4 v181, s[12:15], s28 offen offset:1024 lds
    buffer_load_dwordx4 v182, s[12:15], s28 offen offset:2048 lds
    buffer_load_dwordx4 v183, s[12:15], s28 offen offset:3072 lds
    s_add_u32 s28, s28, 128
    s_add_u32 s30, s30, 32768
    s_cmp_ge_u32 s30, 98304
    s_cselect_b32 s30, s37, s30
    s_waitcnt vmcnt(4)
    s_barrier
    ds_read_b64_tr_b16 v[112:113], v178 offset:0
    ds_read_b64_tr_b16 v[114:115], v178 offset:512
    ds_read_b128 v[96:99], v176 offset:0
    ds_read_b128 v[100:103], v176 offset:2048
    ds_read_b128 v[104:107], v176 offset:4096
    ds_read_b128 v[108:111], v176 offset:6144
    ds_read_b64_tr_b16 v[116:117], v179 offset:0
    ds_read_b64_tr_b16 v[118:119], v179 offset:512
    ds_read_b64_tr_b16 v[120:121], v178 offset:1024
    ds_read_b64_tr_b16 v[122:123], v178 offset:1536
    ds_read_b64_tr_b16 v[124:125], v179 offset:1024
    ds_read_b64_tr_b16 v[126:127], v179 offset:1536
    ds_read_b64_tr_b16 v[128:129], v178 offset:2048
    ds_read_b64_tr_b16 v[130:131], v178 offset:2560
    s_mov_b32 m0, s31
    s_nop 0
    buffer_load_dwordx4 v184, s[16:19], s29 offen offset:0 lds
    s_waitcnt lgkmcnt(8)
    ds_read_b64_tr_b16 v[132:133], v179 offset:2048
    ds_read_b64_tr_b16 v[134:135], v179 offset:2560
    v_mfma_f32_16x16x32_bf16 v[0:3], v[112:115], v[96:99], v[196:199]
    buffer_load_dwordx4 v185, s[16:19], s29 offen offset:1024 lds
    v_mfma_f32_16x16x32_bf16 v[24:27], v[112:115], v[100:103], v[196:199]
    v_mfma_f32_16x16x32_bf16 v[48:51], v[112:115], v[104:107], v[196:199]
    buffer_load_dwordx4 v186, s[16:19], s29 offen offset:2048 lds
    v_mfma_f32_16x16x32_bf16 v[72:75], v[112:115], v[108:111], v[196:199]
    s_waitcnt lgkmcnt(0)
    v_mfma_f32_16x16x32_bf16 v[76:79], v[116:119], v[108:111], v[196:199]
    ds_read_b64_tr_b16 v[152:153], v178 offset:12288
    v_mfma_f32_16x16x32_bf16 v[52:55], v[116:119], v[104:107], v[196:199]
    ds_read_b64_tr_b16 v[154:155], v178 offset:12800
    s_add_u32 s29, s29, 393216
    s_add_u32 s31, s31, 24576
    s_sub_u32 s39, s31, 61440
    s_cmp_ge_u32 s31, 159744
    s_cselect_b32 s31, s39, s31
    s_mov_b32 m0, s30
    s_nop 0
    buffer_load_dwordx4 v180, s[12:15], s28 offen offset:0 lds
    v_mfma_f32_16x16x32_bf16 v[28:31], v[116:119], v[100:103], v[196:199]
    ds_read_b128 v[136:139], v177 offset:0
    v_mfma_f32_16x16x32_bf16 v[4:7], v[116:119], v[96:99], v[196:199]
    ds_read_b128 v[140:143], v177 offset:2048
    v_mfma_f32_16x16x32_bf16 v[8:11], v[96:99], v[120:123], v[196:199]
    ds_read_b128 v[144:147], v177 offset:4096
    buffer_load_dwordx4 v181, s[12:15], s28 offen offset:1024 lds
    v_mfma_f32_16x16x32_bf16 v[32:35], v[100:103], v[120:123], v[196:199]
    ds_read_b128 v[148:151], v177 offset:6144
    v_mfma_f32_16x16x32_bf16 v[56:59], v[104:107], v[120:123], v[196:199]
    ds_read_b64_tr_b16 v[156:157], v179 offset:12288
    v_mfma_f32_16x16x32_bf16 v[80:83], v[108:111], v[120:123], v[196:199]
    ds_read_b64_tr_b16 v[158:159], v179 offset:12800
    buffer_load_dwordx4 v182, s[12:15], s28 offen offset:2048 lds
    v_mfma_f32_16x16x32_bf16 v[84:87], v[108:111], v[124:127], v[196:199]
    ds_read_b64_tr_b16 v[160:161], v178 offset:13312
    v_mfma_f32_16x16x32_bf16 v[60:63], v[104:107], v[124:127], v[196:199]
    ds_read_b64_tr_b16 v[162:163], v178 offset:13824
    buffer_load_dwordx4 v183, s[12:15], s28 offen offset:3072 lds
    v_mfma_f32_16x16x32_bf16 v[36:39], v[100:103], v[124:127], v[196:199]
    ds_read_b64_tr_b16 v[164:165], v179 offset:13312
    v_mfma_f32_16x16x32_bf16 v[12:15], v[96:99], v[124:127], v[196:199]
    ds_read_b64_tr_b16 v[166:167], v179 offset:13824
    v_mfma_f32_16x16x32_bf16 v[16:19], v[96:99], v[128:131], 0
    ds_read_b64_tr_b16 v[168:169], v178 offset:14336
    s_add_u32 s28, s28, 128
    s_add_u32 s30, s30, 32768
    s_cmp_ge_u32 s30, 98304
    s_cselect_b32 s30, s37, s30
    buffer_load_dword v201, v200, s[16:19], s46 offen
    v_mfma_f32_16x16x32_bf16 v[40:43], v[100:103], v[128:131], 0
    ds_read_b64_tr_b16 v[170:171], v178 offset:14848
    v_mfma_f32_16x16x32_bf16 v[64:67], v[104:107], v[128:131], 0
    ds_read_b64_tr_b16 v[172:173], v179 offset:14336
    v_mfma_f32_16x16x32_bf16 v[88:91], v[108:111], v[128:131], 0
    ds_read_b64_tr_b16 v[174:175], v179 offset:14848
    buffer_load_dword v202, v200, s[12:15], s47 offen
    v_mfma_f32_16x16x32_bf16 v[92:95], v[108:111], v[132:135], 0
    v_mfma_f32_16x16x32_bf16 v[68:71], v[104:107], v[132:135], 0
    v_mfma_f32_16x16x32_bf16 v[44:47], v[100:103], v[132:135], 0
    v_add_u32 v178, 24576, v178
    v_add_u32 v179, 24576, v179
    v_add_u32 v176, 32768, v176
    v_add_u32 v177, 32768, v177
    v_mfma_f32_16x16x32_bf16 v[20:23], v[96:99], v[132:135], 0
    s_waitcnt vmcnt(7) lgkmcnt(0)
    s_branch L_qkv_in_0_1
.p2align 6
L_qkv_loop_0_1:
    v_mfma_f32_16x16x32_bf16 v[92:95], v[108:111], v[132:135], v[92:95]
    v_mfma_f32_16x16x32_bf16 v[68:71], v[104:107], v[132:135], v[68:71]
    s_waitcnt vmcnt(7) lgkmcnt(0)
    v_mfma_f32_16x16x32_bf16 v[44:47], v[100:103], v[132:135], v[44:47]
    v_mfma_f32_16x16x32_bf16 v[20:23], v[96:99], v[132:135], v[20:23]
L_qkv_in_0_1:
    s_barrier
    v_mfma_f32_16x16x32_bf16 v[0:3], v[152:155], v[136:139], v[0:3]
    ds_read_b64_tr_b16 v[112:113], v178 offset:0
    s_cmp_eq_u32 s32, 11
    s_cbranch_scc1 L_qkv_cp_0_1
L_qkv_cpr_0_1:
    v_mfma_f32_16x16x32_bf16 v[24:27], v[152:155], v[140:143], v[24:27]
    ds_read_b64_tr_b16 v[114:115], v178 offset:512
    s_mov_b32 m0, s31
    v_mfma_f32_16x16x32_bf16 v[48:51], v[152:155], v[144:147], v[48:51]
    ds_read_b128 v[96:99], v176 offset:0
    buffer_load_dwordx4 v184, s[16:19], s29 offen offset:0 lds
    v_mfma_f32_16x16x32_bf16 v[72:75], v[152:155], v[148:151], v[72:75]
    ds_read_b128 v[100:103], v176 offset:2048
    v_mfma_f32_16x16x32_bf16 v[76:79], v[156:159], v[148:151], v[76:79]
    ds_read_b128 v[104:107], v176 offset:4096
    v_mfma_f32_16x16x32_bf16 v[52:55], v[156:159], v[144:147], v[52:55]
    ds_read_b128 v[108:111], v176 offset:6144
    buffer_load_dwordx4 v185, s[16:19], s29 offen offset:1024 lds
    v_mfma_f32_16x16x32_bf16 v[28:31], v[156:159], v[140:143], v[28:31]
    ds_read_b64_tr_b16 v[116:117], v179 offset:0
    v_mfma_f32_16x16x32_bf16 v[4:7], v[156:159], v[136:139], v[4:7]
    ds_read_b64_tr_b16 v[118:119], v179 offset:512
    v_mfma_f32_16x16x32_bf16 v[8:11], v[136:139], v[160:163], v[8:11]
    ds_read_b64_tr_b16 v[120:121], v178 offset:1024
    buffer_load_dwordx4 v186, s[16:19], s29 offen offset:2048 lds
    v_mfma_f32_16x16x32_bf16 v[32:35], v[140:143], v[160:163], v[32:35]
    ds_read_b64_tr_b16 v[122:123], v178 offset:1536
    v_mfma_f32_16x16x32_bf16 v[56:59], v[144:147], v[160:163], v[56:59]
    ds_read_b64_tr_b16 v[124:125], v179 offset:1024
    v_mfma_f32_16x16x32_bf16 v[80:83], v[148:151], v[160:163], v[80:83]
    ds_read_b64_tr_b16 v[126:127], v179 offset:1536
    v_mfma_f32_16x16x32_bf16 v[84:87], v[148:151], v[164:167], v[84:87]
    ds_read_b64_tr_b16 v[128:129], v178 offset:2048
    s_add_u32 s29, s29, 393216
    s_add_u32 s31, s31, 24576
    v_mfma_f32_16x16x32_bf16 v[60:63], v[144:147], v[164:167], v[60:63]
    ds_read_b64_tr_b16 v[130:131], v178 offset:2560
    s_sub_u32 s39, s31, 61440
    v_mfma_f32_16x16x32_bf16 v[36:39], v[140:143], v[164:167], v[36:39]
    ds_read_b64_tr_b16 v[132:133], v179 offset:2048
    s_cmp_ge_u32 s31, 159744
    v_mfma_f32_16x16x32_bf16 v[12:15], v[136:139], v[164:167], v[12:15]
    ds_read_b64_tr_b16 v[134:135], v179 offset:2560
    s_cselect_b32 s31, s39, s31
    v_mfma_f32_16x16x32_bf16 v[16:19], v[136:139], v[168:171], v[16:19]
    s_add_u32 s36, s36, 1
    s_cmp_eq_u32 s36, 5
    v_mfma_f32_16x16x32_bf16 v[40:43], v[140:143], v[168:171], v[40:43]
    s_cselect_b32 s36, 0, s36
    v_mfma_f32_16x16x32_bf16 v[64:67], v[144:147], v[168:171], v[64:67]
    s_cselect_b32 s34, 4294918144, s52
    v_add_u32 v178, s34, v178
    v_mfma_f32_16x16x32_bf16 v[88:91], v[148:151], v[168:171], v[88:91]
    v_add_u32 v179, s34, v179
    v_mfma_f32_16x16x32_bf16 v[92:95], v[148:151], v[172:175], v[92:95]
    v_mfma_f32_16x16x32_bf16 v[68:71], v[144:147], v[172:175], v[68:71]
    s_waitcnt vmcnt(7) lgkmcnt(0)
    v_mfma_f32_16x16x32_bf16 v[44:47], v[140:143], v[172:175], v[44:47]
    v_mfma_f32_16x16x32_bf16 v[20:23], v[136:139], v[172:175], v[20:23]
    s_barrier
    v_mfma_f32_16x16x32_bf16 v[0:3], v[112:115], v[96:99], v[0:3]
    ds_read_b64_tr_b16 v[152:153], v178 offset:0
    v_mfma_f32_16x16x32_bf16 v[24:27], v[112:115], v[100:103], v[24:27]
    ds_read_b64_tr_b16 v[154:155], v178 offset:512
    s_mov_b32 m0, s30
    v_mfma_f32_16x16x32_bf16 v[48:51], v[112:115], v[104:107], v[48:51]
    ds_read_b128 v[136:139], v177 offset:0
    buffer_load_dwordx4 v180, s[12:15], s28 offen offset:0 lds
    v_mfma_f32_16x16x32_bf16 v[72:75], v[112:115], v[108:111], v[72:75]
    ds_read_b128 v[140:143], v177 offset:2048
    v_mfma_f32_16x16x32_bf16 v[76:79], v[116:119], v[108:111], v[76:79]
    ds_read_b128 v[144:147], v177 offset:4096
    v_mfma_f32_16x16x32_bf16 v[52:55], v[116:119], v[104:107], v[52:55]
    ds_read_b128 v[148:151], v177 offset:6144
    buffer_load_dwordx4 v181, s[12:15], s28 offen offset:1024 lds
    v_mfma_f32_16x16x32_bf16 v[28:31], v[116:119], v[100:103], v[28:31]
    ds_read_b64_tr_b16 v[156:157], v179 offset:0
    v_mfma_f32_16x16x32_bf16 v[4:7], v[116:119], v[96:99], v[4:7]
    ds_read_b64_tr_b16 v[158:159], v179 offset:512
    v_mfma_f32_16x16x32_bf16 v[8:11], v[96:99], v[120:123], v[8:11]
    ds_read_b64_tr_b16 v[160:161], v178 offset:1024
    buffer_load_dwordx4 v182, s[12:15], s28 offen offset:2048 lds
    v_mfma_f32_16x16x32_bf16 v[32:35], v[100:103], v[120:123], v[32:35]
    ds_read_b64_tr_b16 v[162:163], v178 offset:1536
    v_mfma_f32_16x16x32_bf16 v[56:59], v[104:107], v[120:123], v[56:59]
    ds_read_b64_tr_b16 v[164:165], v179 offset:1024
    v_mfma_f32_16x16x32_bf16 v[80:83], v[108:111], v[120:123], v[80:83]
    ds_read_b64_tr_b16 v[166:167], v179 offset:1536
    buffer_load_dwordx4 v183, s[12:15], s28 offen offset:3072 lds
    v_mfma_f32_16x16x32_bf16 v[84:87], v[108:111], v[124:127], v[84:87]
    ds_read_b64_tr_b16 v[168:169], v178 offset:2048
    s_add_u32 s28, s28, 128
    v_mfma_f32_16x16x32_bf16 v[60:63], v[104:107], v[124:127], v[60:63]
    ds_read_b64_tr_b16 v[170:171], v178 offset:2560
    s_add_u32 s30, s30, 32768
    v_mfma_f32_16x16x32_bf16 v[36:39], v[100:103], v[124:127], v[36:39]
    ds_read_b64_tr_b16 v[172:173], v179 offset:2048
    s_cmp_ge_u32 s30, 98304
    v_mfma_f32_16x16x32_bf16 v[12:15], v[96:99], v[124:127], v[12:15]
    ds_read_b64_tr_b16 v[174:175], v179 offset:2560
    s_cselect_b32 s30, s37, s30
    v_mfma_f32_16x16x32_bf16 v[16:19], v[96:99], v[128:131], v[16:19]
    s_add_u32 s36, s36, 1
    s_cmp_eq_u32 s36, 5
    s_cselect_b32 s36, 0, s36
    s_cselect_b32 s34, 4294918144, s52
    v_mfma_f32_16x16x32_bf16 v[40:43], v[100:103], v[128:131], v[40:43]
    v_add_u32 v178, s34, v178
    v_add_u32 v179, s34, v179
    s_add_u32 s35, s35, 1
    v_mfma_f32_16x16x32_bf16 v[64:67], v[104:107], v[128:131], v[64:67]
    s_cmp_eq_u32 s35, 3
    s_cselect_b32 s35, 0, s35
    s_cselect_b32 s33, 4294901760, s53
    v_add_u32 v176, s33, v176
    v_mfma_f32_16x16x32_bf16 v[88:91], v[108:111], v[128:131], v[88:91]
    v_add_u32 v177, s33, v177
    s_add_u32 s32, s32, 1
    s_cmp_lt_u32 s32, 14
    s_cbranch_scc1 L_qkv_loop_0_1
    s_branch L_qkv_epi_0
L_qkv_cp_0_1:
    s_load_dword s58, s[56:57], 0
    buffer_load_dword v203, off, s[20:23], s84 sc1
    s_branch L_qkv_cpr_0_1
L_qkv_ent_1_0:
    s_barrier
    s_mov_b32 m0, s30
    s_nop 0
    buffer_load_dwordx4 v180, s[12:15], s28 offen offset:0 lds
    buffer_load_dwordx4 v181, s[12:15], s28 offen offset:1024 lds
    buffer_load_dwordx4 v182, s[12:15], s28 offen offset:2048 lds
    buffer_load_dwordx4 v183, s[12:15], s28 offen offset:3072 lds
    s_add_u32 s28, s28, 128
    s_add_u32 s30, s30, 32768
    s_cmp_ge_u32 s30, 98304
    s_cselect_b32 s30, s37, s30
    s_waitcnt vmcnt(4)
    s_barrier
    ds_read_b64_tr_b16 v[112:113], v178 offset:0
    ds_read_b64_tr_b16 v[114:115], v178 offset:512
    ds_read_b128 v[96:99], v176 offset:0
    ds_read_b128 v[100:103], v176 offset:2048
    ds_read_b128 v[104:107], v176 offset:4096
    ds_read_b128 v[108:111], v176 offset:6144
    ds_read_b64_tr_b16 v[116:117], v179 offset:0
    ds_read_b64_tr_b16 v[118:119], v179 offset:512
    ds_read_b64_tr_b16 v[120:121], v178 offset:1024
    ds_read_b64_tr_b16 v[122:123], v178 offset:1536
    ds_read_b64_tr_b16 v[124:125], v179 offset:1024
    ds_read_b64_tr_b16 v[126:127], v179 offset:1536
    ds_read_b64_tr_b16 v[128:129], v178 offset:2048
    ds_read_b64_tr_b16 v[130:131], v178 offset:2560
    s_mov_b32 m0, s31
    s_nop 0
    buffer_load_dwordx4 v184, s[16:19], s29 offen offset:0 lds
    s_waitcnt lgkmcnt(8)
    ds_read_b64_tr_b16 v[132:133], v179 offset:2048
    ds_read_b64_tr_b16 v[134:135], v179 offset:2560
    v_mfma_f32_16x16x32_bf16 v[0:3], v[112:115], v[96:99], 0
    buffer_load_dwordx4 v185, s[16:19], s29 offen offset:1024 lds
    v_mfma_f32_16x16x32_bf16 v[24:27], v[112:115], v[100:103], 0
    v_mfma_f32_16x16x32_bf16 v[48:51], v[112:115], v[104:107], 0
    v_mfma_f32_16x16x32_bf16 v[72:75], v[112:115], v[108:111], 0
    s_waitcnt lgkmcnt(0)
    buffer_load_dwordx4 v186, s[16:19], s29 offen offset:2048 lds
    v_mfma_f32_16x16x32_bf16 v[76:79], v[116:119], v[108:111], 0
    ds_read_b64_tr_b16 v[152:153], v178 offset:12288
    v_mfma_f32_16x16x32_bf16 v[52:55], v[116:119], v[104:107], 0
    ds_read_b64_tr_b16 v[154:155], v178 offset:12800
    v_mfma_f32_16x16x32_bf16 v[28:31], v[116:119], v[100:103], 0
    ds_read_b128 v[136:139], v177 offset:0
    s_add_u32 s29, s29, 393216
    s_add_u32 s31, s31, 24576
    s_sub_u32 s39, s31, 61440
    s_cmp_ge_u32 s31, 159744
    s_cselect_b32 s31, s39, s31
    s_mov_b32 m0, s31
    s_nop 0
    buffer_load_dwordx4 v184, s[16:19], s29 offen offset:0 lds
    v_mfma_f32_16x16x32_bf16 v[4:7], v[116:119], v[96:99], 0
    ds_read_b128 v[140:143], v177 offset:2048
    v_mfma_f32_16x16x32_bf16 v[8:11], v[120:123], v[96:99], 0
    ds_read_b128 v[144:147], v177 offset:4096
    v_mfma_f32_16x16x32_bf16 v[32:35], v[120:123], v[100:103], 0
    ds_read_b128 v[148:151], v177 offset:6144
    buffer_load_dwordx4 v185, s[16:19], s29 offen offset:1024 lds
    v_mfma_f32_16x16x32_bf16 v[56:59], v[120:123], v[104:107], 0
    ds_read_b64_tr_b16 v[156:157], v179 offset:12288
    v_mfma_f32_16x16x32_bf16 v[80:83], v[120:123], v[108:111], 0
    ds_read_b64_tr_b16 v[158:159], v179 offset:12800
    v_mfma_f32_16x16x32_bf16 v[84:87], v[124:127], v[108:111], 0
    ds_read_b64_tr_b16 v[160:161], v178 offset:13312
    buffer_load_dwordx4 v186, s[16:19], s29 offen offset:2048 lds
    v_mfma_f32_16x16x32_bf16 v[60:63], v[124:127], v[104:107], 0
    ds_read_b64_tr_b16 v[162:163], v178 offset:13824
    v_mfma_f32_16x16x32_bf16 v[36:39], v[124:127], v[100:103], 0
    ds_read_b64_tr_b16 v[164:165], v179 offset:13312
    v_mfma_f32_16x16x32_bf16 v[12:15], v[124:127], v[96:99], 0
    ds_read_b64_tr_b16 v[166:167], v179 offset:13824
    s_add_u32 s29, s29, 393216
    s_add_u32 s31, s31, 24576
    s_sub_u32 s39, s31, 61440
    s_cmp_ge_u32 s31, 159744
    s_cselect_b32 s31, s39, s31
    buffer_load_dword v201, v200, s[16:19], s46 offen
    v_mfma_f32_16x16x32_bf16 v[16:19], v[96:99], v[128:131], 0
    ds_read_b64_tr_b16 v[168:169], v178 offset:14336
    v_mfma_f32_16x16x32_bf16 v[40:43], v[100:103], v[128:131], 0
    ds_read_b64_tr_b16 v[170:171], v178 offset:14848
    v_mfma_f32_16x16x32_bf16 v[64:67], v[104:107], v[128:131], 0
    ds_read_b64_tr_b16 v[172:173], v179 offset:14336
    buffer_load_dword v202, v200, s[12:15], s47 offen
    v_mfma_f32_16x16x32_bf16 v[88:91], v[108:111], v[128:131], 0
    ds_read_b64_tr_b16 v[174:175], v179 offset:14848
    v_mfma_f32_16x16x32_bf16 v[92:95], v[108:111], v[132:135], 0
    v_mfma_f32_16x16x32_bf16 v[68:71], v[104:107], v[132:135], 0
    v_mfma_f32_16x16x32_bf16 v[44:47], v[100:103], v[132:135], 0
    v_add_u32 v178, 24576, v178
    v_add_u32 v179, 24576, v179
    v_add_u32 v176, 32768, v176
    v_add_u32 v177, 32768, v177
    v_mfma_f32_16x16x32_bf16 v[20:23], v[96:99], v[132:135], 0
    s_waitcnt vmcnt(3) lgkmcnt(0)
    s_branch L_qkv_in_1_0
.p2align 6
L_qkv_loop_1_0:
    v_mfma_f32_16x16x32_bf16 v[92:95], v[108:111], v[132:135], v[92:95]
    v_mfma_f32_16x16x32_bf16 v[68:71], v[104:107], v[132:135], v[68:71]
    s_waitcnt vmcnt(3) lgkmcnt(0)
    v_mfma_f32_16x16x32_bf16 v[44:47], v[100:103], v[132:135], v[44:47]
    v_mfma_f32_16x16x32_bf16 v[20:23], v[96:99], v[132:135], v[20:23]
L_qkv_in_1_0:
    s_barrier
    v_mfma_f32_16x16x32_bf16 v[0:3], v[152:155], v[136:139], v[0:3]
    ds_read_b64_tr_b16 v[112:113], v178 offset:0
    s_cmp_eq_u32 s32, 11
    s_cbranch_scc1 L_qkv_cp_1_0
L_qkv_cpr_1_0:
    v_mfma_f32_16x16x32_bf16 v[24:27], v[152:155], v[140:143], v[24:27]
    ds_read_b64_tr_b16 v[114:115], v178 offset:512
    s_mov_b32 m0, s30
    v_mfma_f32_16x16x32_bf16 v[48:51], v[152:155], v[144:147], v[48:51]
    ds_read_b128 v[96:99], v176 offset:0
    buffer_load_dwordx4 v180, s[12:15], s28 offen offset:0 lds
    v_mfma_f32_16x16x32_bf16 v[72:75], v[152:155], v[148:151], v[72:75]
    ds_read_b128 v[100:103], v176 offset:2048
    v_mfma_f32_16x16x32_bf16 v[76:79], v[156:159], v[148:151], v[76:79]
    ds_read_b128 v[104:107], v176 offset:4096
    v_mfma_f32_16x16x32_bf16 v[52:55], v[156:159], v[144:147], v[52:55]
    ds_read_b128 v[108:111], v176 offset:6144
    buffer_load_dwordx4 v181, s[12:15], s28 offen offset:1024 lds
    v_mfma_f32_16x16x32_bf16 v[28:31], v[156:159], v[140:143], v[28:31]
    ds_read_b64_tr_b16 v[116:117], v179 offset:0
    v_mfma_f32_16x16x32_bf16 v[4:7], v[156:159], v[136:139], v[4:7]
    ds_read_b64_tr_b16 v[118:119], v179 offset:512
    v_mfma_f32_16x16x32_bf16 v[8:11], v[160:163], v[136:139], v[8:11]
    ds_read_b64_tr_b16 v[120:121], v178 offset:1024
    buffer_load_dwordx4 v182, s[12:15], s28 offen offset:2048 lds
    v_mfma_f32_16x16x32_bf16 v[32:35], v[160:163], v[140:143], v[32:35]
    ds_read_b64_tr_b16 v[122:123], v178 offset:1536
    v_mfma_f32_16x16x32_bf16 v[56:59], v[160:163], v[144:147], v[56:59]
    ds_read_b64_tr_b16 v[124:125], v179 offset:1024
    v_mfma_f32_16x16x32_bf16 v[80:83], v[160:163], v[148:151], v[80:83]
    ds_read_b64_tr_b16 v[126:127], v179 offset:1536
    buffer_load_dwordx4 v183, s[12:15], s28 offen offset:3072 lds
    v_mfma_f32_16x16x32_bf16 v[84:87], v[164:167], v[148:151], v[84:87]
    ds_read_b64_tr_b16 v[128:129], v178 offset:2048
    s_add_u32 s28, s28, 128
    v_mfma_f32_16x16x32_bf16 v[60:63], v[164:167], v[144:147], v[60:63]
    ds_read_b64_tr_b16 v[130:131], v178 offset:2560
    s_add_u32 s30, s30, 32768
    v_mfma_f32_16x16x32_bf16 v[36:39], v[164:167], v[140:143], v[36:39]
    ds_read_b64_tr_b16 v[132:133], v179 offset:2048
    s_cmp_ge_u32 s30, 98304
    v_mfma_f32_16x16x32_bf16 v[12:15], v[164:167], v[136:139], v[12:15]
    ds_read_b64_tr_b16 v[134:135], v179 offset:2560
    s_cselect_b32 s30, s37, s30
    v_mfma_f32_16x16x32_bf16 v[16:19], v[136:139], v[168:171], v[16:19]
    s_add_u32 s36, s36, 1
    s_cmp_eq_u32 s36, 5
    v_mfma_f32_16x16x32_bf16 v[40:43], v[140:143], v[168:171], v[40:43]
    s_cselect_b32 s36, 0, s36
    v_mfma_f32_16x16x32_bf16 v[64:67], v[144:147], v[168:171], v[64:67]
    s_cselect_b32 s34, 4294918144, s52
    v_add_u32 v178, s34, v178
    v_mfma_f32_16x16x32_bf16 v[88:91], v[148:151], v[168:171], v[88:91]
    v_add_u32 v179, s34, v179
    v_mfma_f32_16x16x32_bf16 v[92:95], v[148:151], v[172:175], v[92:95]
    v_mfma_f32_16x16x32_bf16 v[68:71], v[144:147], v[172:175], v[68:71]
    s_waitcnt lgkmcnt(0)
    v_mfma_f32_16x16x32_bf16 v[44:47], v[140:143], v[172:175], v[44:47]
    v_mfma_f32_16x16x32_bf16 v[20:23], v[136:139], v[172:175], v[20:23]
    s_barrier
    v_mfma_f32_16x16x32_bf16 v[0:3], v[112:115], v[96:99], v[0:3]
    ds_read_b64_tr_b16 v[152:153], v178 offset:0
    v_mfma_f32_16x16x32_bf16 v[24:27], v[112:115], v[100:103], v[24:27]
    ds_read_b64_tr_b16 v[154:155], v178 offset:512
    s_mov_b32 m0, s31
    v_mfma_f32_16x16x32_bf16 v[48:51], v[112:115], v[104:107], v[48:51]
    ds_read_b128 v[136:139], v177 offset:0
    buffer_load_dwordx4 v184, s[16:19], s29 offen offset:0 lds
    v_mfma_f32_16x16x32_bf16 v[72:75], v[112:115], v[108:111], v[72:75]
    ds_read_b128 v[140:143], v177 offset:2048
    v_mfma_f32_16x16x32_bf16 v[76:79], v[116:119], v[108:111], v[76:79]
    ds_read_b128 v[144:147], v177 offset:4096
    v_mfma_f32_16x16x32_bf16 v[52:55], v[116:119], v[104:107], v[52:55]
    ds_read_b128 v[148:151], v177 offset:6144
    buffer_load_dwordx4 v185, s[16:19], s29 offen offset:1024 lds
    v_mfma_f32_16x16x32_bf16 v[28:31], v[116:119], v[100:103], v[28:31]
    ds_read_b64_tr_b16 v[156:157], v179 offset:0
    v_mfma_f32_16x16x32_bf16 v[4:7], v[116:119], v[96:99], v[4:7]
    ds_read_b64_tr_b16 v[158:159], v179 offset:512
    v_mfma_f32_16x16x32_bf16 v[8:11], v[120:123], v[96:99], v[8:11]
    ds_read_b64_tr_b16 v[160:161], v178 offset:1024
    buffer_load_dwordx4 v186, s[16:19], s29 offen offset:2048 lds
    v_mfma_f32_16x16x32_bf16 v[32:35], v[120:123], v[100:103], v[32:35]
    ds_read_b64_tr_b16 v[162:163], v178 offset:1536
    v_mfma_f32_16x16x32_bf16 v[56:59], v[120:123], v[104:107], v[56:59]
    ds_read_b64_tr_b16 v[164:165], v179 offset:1024
    v_mfma_f32_16x16x32_bf16 v[80:83], v[120:123], v[108:111], v[80:83]
    ds_read_b64_tr_b16 v[166:167], v179 offset:1536
    v_mfma_f32_16x16x32_bf16 v[84:87], v[124:127], v[108:111], v[84:87]
    ds_read_b64_tr_b16 v[168:169], v178 offset:2048
    s_add_u32 s29, s29, 393216
    s_add_u32 s31, s31, 24576
    v_mfma_f32_16x16x32_bf16 v[60:63], v[124:127], v[104:107], v[60:63]
    ds_read_b64_tr_b16 v[170:171], v178 offset:2560
    s_sub_u32 s39, s31, 61440
    v_mfma_f32_16x16x32_bf16 v[36:39], v[124:127], v[100:103], v[36:39]
    ds_read_b64_tr_b16 v[172:173], v179 offset:2048
    s_cmp_ge_u32 s31, 159744
    v_mfma_f32_16x16x32_bf16 v[12:15], v[124:127], v[96:99], v[12:15]
    ds_read_b64_tr_b16 v[174:175], v179 offset:2560
    s_cselect_b32 s31, s39, s31
    v_mfma_f32_16x16x32_bf16 v[16:19], v[96:99], v[128:131], v[16:19]
    s_add_u32 s36, s36, 1
    s_cmp_eq_u32 s36, 5
    s_cselect_b32 s36, 0, s36
    s_cselect_b32 s34, 4294918144, s52
    v_mfma_f32_16x16x32_bf16 v[40:43], v[100:103], v[128:131], v[40:43]
    v_add_u32 v178, s34, v178
    v_add_u32 v179, s34, v179
    s_add_u32 s35, s35, 1
    v_mfma_f32_16x16x32_bf16 v[64:67], v[104:107], v[128:131], v[64:67]
    s_cmp_eq_u32 s35, 3
    s_cselect_b32 s35, 0, s35
    s_cselect_b32 s33, 4294901760, s53
    v_add_u32 v176, s33, v176
    v_mfma_f32_16x16x32_bf16 v[88:91], v[108:111], v[128:131], v[88:91]
    v_add_u32 v177, s33, v177
    s_add_u32 s32, s32, 1
    s_cmp_lt_u32 s32, 14
    s_cbranch_scc1 L_qkv_loop_1_0
    s_branch L_qkv_epi_1
L_qkv_cp_1_0:
    s_load_dword s58, s[56:57], 0
    buffer_load_dword v203, off, s[20:23], s84 sc1
    s_branch L_qkv_cpr_1_0
L_qkv_ent_1_1:
    s_barrier
    s_mov_b32 m0, s30
    s_nop 0
    buffer_load_dwordx4 v180, s[12:15], s28 offen offset:0 lds
    buffer_load_dwordx4 v181, s[12:15], s28 offen offset:1024 lds
    buffer_load_dwordx4 v182, s[12:15], s28 offen offset:2048 lds
    buffer_load_dwordx4 v183, s[12:15], s28 offen offset:3072 lds
    s_add_u32 s28, s28, 128
    s_add_u32 s30, s30, 32768
    s_cmp_ge_u32 s30, 98304
    s_cselect_b32 s30, s37, s30
    s_waitcnt vmcnt(4)
    s_barrier
    ds_read_b64_tr_b16 v[112:113], v178 offset:0
    ds_read_b64_tr_b16 v[114:115], v178 offset:512
    ds_read_b128 v[96:99], v176 offset:0
    ds_read_b128 v[100:103], v176 offset:2048
    ds_read_b128 v[104:107], v176 offset:4096
    ds_read_b128 v[108:111], v176 offset:6144
    ds_read_b64_tr_b16 v[116:117], v179 offset:0
    ds_read_b64_tr_b16 v[118:119], v179 offset:512
    ds_read_b64_tr_b16 v[120:121], v178 offset:1024
    ds_read_b64_tr_b16 v[122:123], v178 offset:1536
    ds_read_b64_tr_b16 v[124:125], v179 offset:1024
    ds_read_b64_tr_b16 v[126:127], v179 offset:1536
    ds_read_b64_tr_b16 v[128:129], v178 offset:2048
    ds_read_b64_tr_b16 v[130:131], v178 offset:2560
    s_mov_b32 m0, s31
    s_nop 0
    buffer_load_dwordx4 v184, s[16:19], s29 offen offset:0 lds
    s_waitcnt lgkmcnt(8)
    ds_read_b64_tr_b16 v[132:133], v179 offset:2048
    ds_read_b64_tr_b16 v[134:135], v179 offset:2560
    v_mfma_f32_16x16x32_bf16 v[0:3], v[112:115], v[96:99], 0
    buffer_load_dwordx4 v185, s[16:19], s29 offen offset:1024 lds
    v_mfma_f32_16x16x32_bf16 v[24:27], v[112:115], v[100:103], 0
    v_mfma_f32_16x16x32_bf16 v[48:51], v[112:115], v[104:107], 0
    buffer_load_dwordx4 v186, s[16:19], s29 offen offset:2048 lds
    v_mfma_f32_16x16x32_bf16 v[72:75], v[112:115], v[108:111], 0
    s_waitcnt lgkmcnt(0)
    v_mfma_f32_16x16x32_bf16 v[76:79], v[116:119], v[108:111], 0
    ds_read_b64_tr_b16 v[152:153], v178 offset:12288
    v_mfma_f32_16x16x32_bf16 v[52:55], v[116:119], v[104:107], 0
    ds_read_b64_tr_b16 v[154:155], v178 offset:12800
    s_add_u32 s29, s29, 393216
    s_add_u32 s31, s31, 24576
    s_sub_u32 s39, s31, 61440
    s_cmp_ge_u32 s31, 159744
    s_cselect_b32 s31, s39, s31
    s_mov_b32 m0, s30
    s_nop 0
    buffer_load_dwordx4 v180, s[12:15], s28 offen offset:0 lds
    v_mfma_f32_16x16x32_bf16 v[28:31], v[116:119], v[100:103], 0
    ds_read_b128 v[136:139], v177 offset:0
    v_mfma_f32_16x16x32_bf16 v[4:7], v[116:119], v[96:99], 0
    ds_read_b128 v[140:143], v177 offset:2048
    v_mfma_f32_16x16x32_bf16 v[8:11], v[120:123], v[96:99], 0
    ds_read_b128 v[144:147], v177 offset:4096
    buffer_load_dwordx4 v181, s[12:15], s28 offen offset:1024 lds
    v_mfma_f32_16x16x32_bf16 v[32:35], v[120:123], v[100:103], 0
    ds_read_b128 v[148:151], v177 offset:6144
    v_mfma_f32_16x16x32_bf16 v[56:59], v[120:123], v[104:107], 0
    ds_read_b64_tr_b16 v[156:157], v179 offset:12288
    v_mfma_f32_16x16x32_bf16 v[80:83], v[120:123], v[108:111], 0
    ds_read_b64_tr_b16 v[158:159], v179 offset:12800
    buffer_load_dwordx4 v182, s[12:15], s28 offen offset:2048 lds
    v_mfma_f32_16x16x32_bf16 v[84:87], v[124:127], v[108:111], 0
    ds_read_b64_tr_b16 v[160:161], v178 offset:13312
    v_mfma_f32_16x16x32_bf16 v[60:63], v[124:127], v[104:107], 0
    ds_read_b64_tr_b16 v[162:163], v178 offset:13824
    buffer_load_dwordx4 v183, s[12:15], s28 offen offset:3072 lds
    v_mfma_f32_16x16x32_bf16 v[36:39], v[124:127], v[100:103], 0
    ds_read_b64_tr_b16 v[164:165], v179 offset:13312
    v_mfma_f32_16x16x32_bf16 v[12:15], v[124:127], v[96:99], 0
    ds_read_b64_tr_b16 v[166:167], v179 offset:13824
    v_mfma_f32_16x16x32_bf16 v[16:19], v[96:99], v[128:131], 0
    ds_read_b64_tr_b16 v[168:169], v178 offset:14336
    s_add_u32 s28, s28, 128
    s_add_u32 s30, s30, 32768
    s_cmp_ge_u32 s30, 98304
    s_cselect_b32 s30, s37, s30
    buffer_load_dword v201, v200, s[16:19], s46 offen
    v_mfma_f32_16x16x32_bf16 v[40:43], v[100:103], v[128:131], 0
    ds_read_b64_tr_b16 v[170:171], v178 offset:14848
    v_mfma_f32_16x16x32_bf16 v[64:67], v[104:107], v[128:131], 0
    ds_read_b64_tr_b16 v[172:173], v179 offset:14336
    v_mfma_f32_16x16x32_bf16 v[88:91], v[108:111], v[128:131], 0
    ds_read_b64_tr_b16 v[174:175], v179 offset:14848
    buffer_load_dword v202, v200, s[12:15], s47 offen
    v_mfma_f32_16x16x32_bf16 v[92:95], v[108:111], v[132:135], 0
    v_mfma_f32_16x16x32_bf16 v[68:71], v[104:107], v[132:135], 0
    v_mfma_f32_16x16x32_bf16 v[44:47], v[100:103], v[132:135], 0
    v_add_u32 v178, 24576, v178
    v_add_u32 v179, 24576, v179
    v_add_u32 v176, 32768, v176
    v_add_u32 v177, 32768, v177
    v_mfma_f32_16x16x32_bf16 v[20:23], v[96:99], v[132:135], 0
    s_waitcnt vmcnt(7) lgkmcnt(0)
    s_branch L_qkv_in_1_1
.p2align 6
L_qkv_loop_1_1:
    v_mfma_f32_16x16x32_bf16 v[92:95], v[108:111], v[132:135], v[92:95]
    v_mfma_f32_16x16x32_bf16 v[68:71], v[104:107], v[132:135], v[68:71]
    s_waitcnt vmcnt(7) lgkmcnt(0)
    v_mfma_f32_16x16x32_bf16 v[44:47], v[100:103], v[132:135], v[44:47]
    v_mfma_f32_16x16x32_bf16 v[20:23], v[96:99], v[132:135], v[20:23]
L_qkv_in_1_1:
    s_barrier
    v_mfma_f32_16x16x32_bf16 v[0:3], v[152:155], v[136:139], v[0:3]
    ds_read_b64_tr_b16 v[112:113], v178 offset:0
    s_cmp_eq_u32 s32, 11
    s_cbranch_scc1 L_qkv_cp_1_1
L_qkv_cpr_1_1:
    v_mfma_f32_16x16x32_bf16 v[24:27], v[152:155], v[140:143], v[24:27]
    ds_read_b64_tr_b16 v[114:115], v178 offset:512
    s_mov_b32 m0, s31
    v_mfma_f32_16x16x32_bf16 v[48:51], v[152:155], v[144:147], v[48:51]
    ds_read_b128 v[96:99], v176 offset:0
    buffer_load_dwordx4 v184, s[16:19], s29 offen offset:0 lds
    v_mfma_f32_16x16x32_bf16 v[72:75], v[152:155], v[148:151], v[72:75]
    ds_read_b128 v[100:103], v176 offset:2048
    v_mfma_f32_16x16x32_bf16 v[76:79], v[156:159], v[148:151], v[76:79]
    ds_read_b128 v[104:107], v176 offset:4096
    v_mfma_f32_16x16x32_bf16 v[52:55], v[156:159], v[144:147], v[52:55]
    ds_read_b128 v[108:111], v176 offset:6144
    buffer_load_dwordx4 v185, s[16:19], s29 offen offset:1024 lds
    v_mfma_f32_16x16x32_bf16 v[28:31], v[156:159], v[140:143], v[28:31]
    ds_read_b64_tr_b16 v[116:117], v179 offset:0
    v_mfma_f32_16x16x32_bf16 v[4:7], v[156:159], v[136:139], v[4:7]
    ds_read_b64_tr_b16 v[118:119], v179 offset:512
    v_mfma_f32_16x16x32_bf16 v[8:11], v[160:163], v[136:139], v[8:11]
    ds_read_b64_tr_b16 v[120:121], v178 offset:1024
    buffer_load_dwordx4 v186, s[16:19], s29 offen offset:2048 lds
    v_mfma_f32_16x16x32_bf16 v[32:35], v[160:163], v[140:143], v[32:35]
    ds_read_b64_tr_b16 v[122:123], v178 offset:1536
    v_mfma_f32_16x16x32_bf16 v[56:59], v[160:163], v[144:147], v[56:59]
    ds_read_b64_tr_b16 v[124:125], v179 offset:1024
    v_mfma_f32_16x16x32_bf16 v[80:83], v[160:163], v[148:151], v[80:83]
    ds_read_b64_tr_b16 v[126:127], v179 offset:1536
    v_mfma_f32_16x16x32_bf16 v[84:87], v[164:167], v[148:151], v[84:87]
    ds_read_b64_tr_b16 v[128:129], v178 offset:2048
    s_add_u32 s29, s29, 393216
    s_add_u32 s31, s31, 24576
    v_mfma_f32_16x16x32_bf16 v[60:63], v[164:167], v[144:147], v[60:63]
    ds_read_b64_tr_b16 v[130:131], v178 offset:2560
    s_sub_u32 s39, s31, 61440
    v_mfma_f32_16x16x32_bf16 v[36:39], v[164:167], v[140:143], v[36:39]
    ds_read_b64_tr_b16 v[132:133], v179 offset:2048
    s_cmp_ge_u32 s31, 159744
    v_mfma_f32_16x16x32_bf16 v[12:15], v[164:167], v[136:139], v[12:15]
    ds_read_b64_tr_b16 v[134:135], v179 offset:2560
    s_cselect_b32 s31, s39, s31
    v_mfma_f32_16x16x32_bf16 v[16:19], v[136:139], v[168:171], v[16:19]
    s_add_u32 s36, s36, 1
    s_cmp_eq_u32 s36, 5
    v_mfma_f32_16x16x32_bf16 v[40:43], v[140:143], v[168:171], v[40:43]
    s_cselect_b32 s36, 0, s36
    v_mfma_f32_16x16x32_bf16 v[64:67], v[144:147], v[168:171], v[64:67]
    s_cselect_b32 s34, 4294918144, s52
    v_add_u32 v178, s34, v178
    v_mfma_f32_16x16x32_bf16 v[88:91], v[148:151], v[168:171], v[88:91]
    v_add_u32 v179, s34, v179
    v_mfma_f32_16x16x32_bf16 v[92:95], v[148:151], v[172:175], v[92:95]
    v_mfma_f32_16x16x32_bf16 v[68:71], v[144:147], v[172:175], v[68:71]
    s_waitcnt vmcnt(7) lgkmcnt(0)
    v_mfma_f32_16x16x32_bf16 v[44:47], v[140:143], v[172:175], v[44:47]
    v_mfma_f32_16x16x32_bf16 v[20:23], v[136:139], v[172:175], v[20:23]
    s_barrier
    v_mfma_f32_16x16x32_bf16 v[0:3], v[112:115], v[96:99], v[0:3]
    ds_read_b64_tr_b16 v[152:153], v178 offset:0
    v_mfma_f32_16x16x32_bf16 v[24:27], v[112:115], v[100:103], v[24:27]
    ds_read_b64_tr_b16 v[154:155], v178 offset:512
    s_mov_b32 m0, s30
    v_mfma_f32_16x16x32_bf16 v[48:51], v[112:115], v[104:107], v[48:51]
    ds_read_b128 v[136:139], v177 offset:0
    buffer_load_dwordx4 v180, s[12:15], s28 offen offset:0 lds
    v_mfma_f32_16x16x32_bf16 v[72:75], v[112:115], v[108:111], v[72:75]
    ds_read_b128 v[140:143], v177 offset:2048
    v_mfma_f32_16x16x32_bf16 v[76:79], v[116:119], v[108:111], v[76:79]
    ds_read_b128 v[144:147], v177 offset:4096
    v_mfma_f32_16x16x32_bf16 v[52:55], v[116:119], v[104:107], v[52:55]
    ds_read_b128 v[148:151], v177 offset:6144
    buffer_load_dwordx4 v181, s[12:15], s28 offen offset:1024 lds
    v_mfma_f32_16x16x32_bf16 v[28:31], v[116:119], v[100:103], v[28:31]
    ds_read_b64_tr_b16 v[156:157], v179 offset:0
    v_mfma_f32_16x16x32_bf16 v[4:7], v[116:119], v[96:99], v[4:7]
    ds_read_b64_tr_b16 v[158:159], v179 offset:512
    v_mfma_f32_16x16x32_bf16 v[8:11], v[120:123], v[96:99], v[8:11]
    ds_read_b64_tr_b16 v[160:161], v178 offset:1024
    buffer_load_dwordx4 v182, s[12:15], s28 offen offset:2048 lds
    v_mfma_f32_16x16x32_bf16 v[32:35], v[120:123], v[100:103], v[32:35]
    ds_read_b64_tr_b16 v[162:163], v178 offset:1536
    v_mfma_f32_16x16x32_bf16 v[56:59], v[120:123], v[104:107], v[56:59]
    ds_read_b64_tr_b16 v[164:165], v179 offset:1024
    v_mfma_f32_16x16x32_bf16 v[80:83], v[120:123], v[108:111], v[80:83]
    ds_read_b64_tr_b16 v[166:167], v179 offset:1536
    buffer_load_dwordx4 v183, s[12:15], s28 offen offset:3072 lds
    v_mfma_f32_16x16x32_bf16 v[84:87], v[124:127], v[108:111], v[84:87]
    ds_read_b64_tr_b16 v[168:169], v178 offset:2048
    s_add_u32 s28, s28, 128
    v_mfma_f32_16x16x32_bf16 v[60:63], v[124:127], v[104:107], v[60:63]
    ds_read_b64_tr_b16 v[170:171], v178 offset:2560
    s_add_u32 s30, s30, 32768
    v_mfma_f32_16x16x32_bf16 v[36:39], v[124:127], v[100:103], v[36:39]
    ds_read_b64_tr_b16 v[172:173], v179 offset:2048
    s_cmp_ge_u32 s30, 98304
    v_mfma_f32_16x16x32_bf16 v[12:15], v[124:127], v[96:99], v[12:15]
    ds_read_b64_tr_b16 v[174:175], v179 offset:2560
    s_cselect_b32 s30, s37, s30
    v_mfma_f32_16x16x32_bf16 v[16:19], v[96:99], v[128:131], v[16:19]
    s_add_u32 s36, s36, 1
    s_cmp_eq_u32 s36, 5
    s_cselect_b32 s36, 0, s36
    s_cselect_b32 s34, 4294918144, s52
    v_mfma_f32_16x16x32_bf16 v[40:43], v[100:103], v[128:131], v[40:43]
    v_add_u32 v178, s34, v178
    v_add_u32 v179, s34, v179
    s_add_u32 s35, s35, 1
    v_mfma_f32_16x16x32_bf16 v[64:67], v[104:107], v[128:131], v[64:67]
    s_cmp_eq_u32 s35, 3
    s_cselect_b32 s35, 0, s35
    s_cselect_b32 s33, 4294901760, s53
    v_add_u32 v176, s33, v176
    v_mfma_f32_16x16x32_bf16 v[88:91], v[108:111], v[128:131], v[88:91]
    v_add_u32 v177, s33, v177
    s_add_u32 s32, s32, 1
    s_cmp_lt_u32 s32, 14
    s_cbranch_scc1 L_qkv_loop_1_1
    s_branch L_qkv_epi_1
L_qkv_cp_1_1:
    s_load_dword s58, s[56:57], 0
    buffer_load_dword v203, off, s[20:23], s84 sc1
    s_branch L_qkv_cpr_1_1
L_qkv_epi_1:
    v_subrev_u32 v178, 36864, v178
    v_subrev_u32 v179, 36864, v179
    v_subrev_u32 v204, 65536, v176
    v_subrev_u32 v205, 65536, v177
    v_mfma_f32_16x16x32_bf16 v[92:95], v[108:111], v[132:135], v[92:95]
    v_mfma_f32_16x16x32_bf16 v[68:71], v[104:107], v[132:135], v[68:71]
    v_mfma_f32_16x16x32_bf16 v[44:47], v[100:103], v[132:135], v[44:47]
    v_mfma_f32_16x16x32_bf16 v[20:23], v[96:99], v[132:135], v[20:23]
    s_waitcnt vmcnt(3) lgkmcnt(0)
    s_barrier
    v_mfma_f32_16x16x32_bf16 v[0:3], v[152:155], v[136:139], v[0:3]
    s_cmp_ge_u32 s27, 4
    s_cbranch_scc1 L_qkv_t1_1
    s_mov_b32 m0, s30
    s_nop 0
    buffer_load_dwordx4 v180, s[12:15], s28 offen offset:0 lds
    buffer_load_dwordx4 v181, s[12:15], s28 offen offset:1024 lds
    buffer_load_dwordx4 v182, s[12:15], s28 offen offset:2048 lds
    buffer_load_dwordx4 v183, s[12:15], s28 offen offset:3072 lds
    s_branch L_qkv_t2_1
L_qkv_t1_1:
    s_mov_b32 m0, s31
    s_nop 0
    buffer_load_dwordx4 v184, s[16:19], s29 offen offset:0 lds
    buffer_load_dwordx4 v185, s[16:19], s29 offen offset:1024 lds
    buffer_load_dwordx4 v186, s[16:19], s29 offen offset:2048 lds
L_qkv_t2_1:
    ds_read_b64_tr_b16 v[128:129], v178 offset:36864
    v_mfma_f32_16x16x32_bf16 v[24:27], v[152:155], v[140:143], v[24:27]
    ds_read_b64_tr_b16 v[130:131], v178 offset:37376
    v_mfma_f32_16x16x32_bf16 v[48:51], v[152:155], v[144:147], v[48:51]
    ds_read_b64_tr_b16 v[132:133], v179 offset:36864
    v_mfma_f32_16x16x32_bf16 v[72:75], v[152:155], v[148:151], v[72:75]
    ds_read_b64_tr_b16 v[134:135], v179 offset:37376
    v_mfma_f32_16x16x32_bf16 v[76:79], v[156:159], v[148:151], v[76:79]
    ds_read_b128 v[96:99], v176 offset:0
    v_mfma_f32_16x16x32_bf16 v[52:55], v[156:159], v[144:147], v[52:55]
    ds_read_b128 v[100:103], v176 offset:2048
    v_mfma_f32_16x16x32_bf16 v[28:31], v[156:159], v[140:143], v[28:31]
    ds_read_b128 v[104:107], v176 offset:4096
    v_mfma_f32_16x16x32_bf16 v[4:7], v[156:159], v[136:139], v[4:7]
    ds_read_b128 v[108:111], v176 offset:6144
    v_mfma_f32_16x16x32_bf16 v[8:11], v[160:163], v[136:139], v[8:11]
    ds_read_b64_tr_b16 v[208:209], v178 offset:49152
    v_mfma_f32_16x16x32_bf16 v[32:35], v[160:163], v[140:143], v[32:35]
    ds_read_b64_tr_b16 v[210:211], v178 offset:49664
    v_mfma_f32_16x16x32_bf16 v[56:59], v[160:163], v[144:147], v[56:59]
    ds_read_b64_tr_b16 v[212:213], v179 offset:49152
    v_mfma_f32_16x16x32_bf16 v[80:83], v[160:163], v[148:151], v[80:83]
    ds_read_b64_tr_b16 v[214:215], v179 offset:49664
    v_mfma_f32_16x16x32_bf16 v[84:87], v[164:167], v[148:151], v[84:87]
    ds_read_b128 v[112:115], v177 offset:0
    v_mfma_f32_16x16x32_bf16 v[60:63], v[164:167], v[144:147], v[60:63]
    ds_read_b128 v[116:119], v177 offset:2048
    v_mfma_f32_16x16x32_bf16 v[36:39], v[164:167], v[140:143], v[36:39]
    ds_read_b128 v[120:123], v177 offset:4096
    v_mfma_f32_16x16x32_bf16 v[12:15], v[164:167], v[136:139], v[12:15]
    ds_read_b128 v[124:127], v177 offset:6144
    v_mfma_f32_16x16x32_bf16 v[16:19], v[136:139], v[168:171], v[16:19]
    v_mfma_f32_16x16x32_bf16 v[40:43], v[140:143], v[168:171], v[40:43]
    v_mfma_f32_16x16x32_bf16 v[64:67], v[144:147], v[168:171], v[64:67]
    v_mfma_f32_16x16x32_bf16 v[88:91], v[148:151], v[168:171], v[88:91]
    v_mfma_f32_16x16x32_bf16 v[92:95], v[148:151], v[172:175], v[92:95]
    v_mfma_f32_16x16x32_bf16 v[68:71], v[144:147], v[172:175], v[68:71]
    v_mfma_f32_16x16x32_bf16 v[44:47], v[140:143], v[172:175], v[44:47]
    v_mfma_f32_16x16x32_bf16 v[20:23], v[136:139], v[172:175], v[20:23]
    s_waitcnt lgkmcnt(0)
    v_mfma_f32_16x16x32_bf16 v[0:3], v[128:131], v[96:99], v[0:3]
    ds_read_b64_tr_b16 v[168:169], v178 offset:37888
    v_mfma_f32_16x16x32_bf16 v[24:27], v[128:131], v[100:103], v[24:27]
    ds_read_b64_tr_b16 v[170:171], v178 offset:38400
    v_mfma_f32_16x16x32_bf16 v[48:51], v[128:131], v[104:107], v[48:51]
    ds_read_b64_tr_b16 v[172:173], v179 offset:37888
    v_mfma_f32_16x16x32_bf16 v[72:75], v[128:131], v[108:111], v[72:75]
    ds_read_b64_tr_b16 v[174:175], v179 offset:38400
    v_mfma_f32_16x16x32_bf16 v[76:79], v[132:135], v[108:111], v[76:79]
    v_mfma_f32_16x16x32_bf16 v[52:55], v[132:135], v[104:107], v[52:55]
    v_mfma_f32_16x16x32_bf16 v[28:31], v[132:135], v[100:103], v[28:31]
    v_mfma_f32_16x16x32_bf16 v[4:7], v[132:135], v[96:99], v[4:7]
    s_waitcnt lgkmcnt(4)
    v_mfma_f32_16x16x32_bf16 v[0:3], v[208:211], v[112:115], v[0:3]
    ds_read_b64_tr_b16 v[216:217], v178 offset:50176
    v_mfma_f32_16x16x32_bf16 v[24:27], v[208:211], v[116:119], v[24:27]
    ds_read_b64_tr_b16 v[218:219], v178 offset:50688
    v_mfma_f32_16x16x32_bf16 v[48:51], v[208:211], v[120:123], v[48:51]
    ds_read_b64_tr_b16 v[220:221], v179 offset:50176
    v_mfma_f32_16x16x32_bf16 v[72:75], v[208:211], v[124:127], v[72:75]
    ds_read_b64_tr_b16 v[222:223], v179 offset:50688
    v_mfma_f32_16x16x32_bf16 v[76:79], v[212:215], v[124:127], v[76:79]
    v_mfma_f32_16x16x32_bf16 v[52:55], v[212:215], v[120:123], v[52:55]
    v_mfma_f32_16x16x32_bf16 v[28:31], v[212:215], v[116:119], v[28:31]
    v_mfma_f32_16x16x32_bf16 v[4:7], v[212:215], v[112:115], v[4:7]
    s_waitcnt vmcnt(0) lgkmcnt(4)
    s_barrier
    v_readfirstlane_b32 s82, v203
    v_mfma_f32_16x16x32_bf16 v[8:11], v[168:171], v[96:99], v[8:11]
    ds_read_b64_tr_b16 v[128:129], v178 offset:0
    v_mfma_f32_16x16x32_bf16 v[32:35], v[168:171], v[100:103], v[32:35]
    ds_read_b64_tr_b16 v[130:131], v178 offset:512
    v_mfma_f32_16x16x32_bf16 v[56:59], v[168:171], v[104:107], v[56:59]
    ds_read_b64_tr_b16 v[132:133], v179 offset:0
    v_mfma_f32_16x16x32_bf16 v[80:83], v[168:171], v[108:111], v[80:83]
    ds_read_b64_tr_b16 v[134:135], v179 offset:512
    v_mfma_f32_16x16x32_bf16 v[84:87], v[172:175], v[108:111], v[84:87]
    ds_read_b128 v[136:139], v204 offset:0
    v_mfma_f32_16x16x32_bf16 v[60:63], v[172:175], v[104:107], v[60:63]
    ds_read_b128 v[140:143], v204 offset:2048
    v_mfma_f32_16x16x32_bf16 v[36:39], v[172:175], v[100:103], v[36:39]
    ds_read_b128 v[144:147], v204 offset:4096
    v_mfma_f32_16x16x32_bf16 v[12:15], v[172:175], v[96:99], v[12:15]
    ds_read_b128 v[148:151], v204 offset:6144
    s_waitcnt lgkmcnt(8)
    v_mfma_f32_16x16x32_bf16 v[8:11], v[216:219], v[112:115], v[8:11]
    ds_read_b64_tr_b16 v[208:209], v178 offset:12288
    v_mfma_f32_16x16x32_bf16 v[32:35], v[216:219], v[116:119], v[32:35]
    ds_read_b64_tr_b16 v[210:211], v178 offset:12800
    v_mfma_f32_16x16x32_bf16 v[56:59], v[216:219], v[120:123], v[56:59]
    ds_read_b64_tr_b16 v[212:213], v179 offset:12288
    v_mfma_f32_16x16x32_bf16 v[80:83], v[216:219], v[124:127], v[80:83]
    ds_read_b64_tr_b16 v[214:215], v179 offset:12800
    v_mfma_f32_16x16x32_bf16 v[84:87], v[220:223], v[124:127], v[84:87]
    ds_read_b128 v[152:155], v205 offset:0
    v_mfma_f32_16x16x32_bf16 v[60:63], v[220:223], v[120:123], v[60:63]
    ds_read_b128 v[156:159], v205 offset:2048
    v_mfma_f32_16x16x32_bf16 v[36:39], v[220:223], v[116:119], v[36:39]
    ds_read_b128 v[160:163], v205 offset:4096
    v_mfma_f32_16x16x32_bf16 v[12:15], v[220:223], v[112:115], v[12:15]
    ds_read_b128 v[164:167], v205 offset:6144
    s_waitcnt lgkmcnt(8)
    v_mfma_f32_16x16x32_bf16 v[0:3], v[128:131], v[136:139], v[0:3]
    ds_read_b64_tr_b16 v[168:169], v178 offset:1024
    v_mfma_f32_16x16x32_bf16 v[24:27], v[128:131], v[140:143], v[24:27]
    ds_read_b64_tr_b16 v[170:171], v178 offset:1536
    v_mfma_f32_16x16x32_bf16 v[48:51], v[128:131], v[144:147], v[48:51]
    ds_read_b64_tr_b16 v[172:173], v179 offset:1024
    v_mfma_f32_16x16x32_bf16 v[72:75], v[128:131], v[148:151], v[72:75]
    ds_read_b64_tr_b16 v[174:175], v179 offset:1536
    v_mfma_f32_16x16x32_bf16 v[76:79], v[132:135], v[148:151], v[76:79]
    v_mfma_f32_16x16x32_bf16 v[52:55], v[132:135], v[144:147], v[52:55]
    v_mfma_f32_16x16x32_bf16 v[28:31], v[132:135], v[140:143], v[28:31]
    v_mfma_f32_16x16x32_bf16 v[4:7], v[132:135], v[136:139], v[4:7]
    s_waitcnt lgkmcnt(4)
    v_mfma_f32_16x16x32_bf16 v[0:3], v[208:211], v[152:155], v[0:3]
    ds_read_b64_tr_b16 v[216:217], v178 offset:13312
    v_mfma_f32_16x16x32_bf16 v[24:27], v[208:211], v[156:159], v[24:27]
    ds_read_b64_tr_b16 v[218:219], v178 offset:13824
    v_mfma_f32_16x16x32_bf16 v[48:51], v[208:211], v[160:163], v[48:51]
    ds_read_b64_tr_b16 v[220:221], v179 offset:13312
    v_mfma_f32_16x16x32_bf16 v[72:75], v[208:211], v[164:167], v[72:75]
    ds_read_b64_tr_b16 v[222:223], v179 offset:13824
    v_mfma_f32_16x16x32_bf16 v[76:79], v[212:215], v[164:167], v[76:79]
    v_mfma_f32_16x16x32_bf16 v[52:55], v[212:215], v[160:163], v[52:55]
    v_mfma_f32_16x16x32_bf16 v[28:31], v[212:215], v[156:159], v[28:31]
    v_mfma_f32_16x16x32_bf16 v[4:7], v[212:215], v[152:155], v[4:7]
    s_waitcnt lgkmcnt(4)
    v_mfma_f32_16x16x32_bf16 v[8:11], v[168:171], v[136:139], v[8:11]
    ds_read_b64_tr_b16 v[128:129], v178 offset:38912
    v_mfma_f32_16x16x32_bf16 v[32:35], v[168:171], v[140:143], v[32:35]
    ds_read_b64_tr_b16 v[130:131], v178 offset:39424
    v_mfma_f32_16x16x32_bf16 v[56:59], v[168:171], v[144:147], v[56:59]
    ds_read_b64_tr_b16 v[132:133], v179 offset:38912
    v_mfma_f32_16x16x32_bf16 v[80:83], v[168:171], v[148:151], v[80:83]
    ds_read_b64_tr_b16 v[134:135], v179 offset:39424
    v_mfma_f32_16x16x32_bf16 v[84:87], v[172:175], v[148:151], v[84:87]
    v_mfma_f32_16x16x32_bf16 v[60:63], v[172:175], v[144:147], v[60:63]
    v_pk_mul_f32 v[72:73], v[72:73], s[44:45]
    v_mfma_f32_16x16x32_bf16 v[36:39], v[172:175], v[140:143], v[36:39]
    v_pk_mul_f32 v[74:75], v[74:75], s[44:45]
    v_pk_mul_f32 v[76:77], v[76:77], s[44:45]
    v_mfma_f32_16x16x32_bf16 v[12:15], v[172:175], v[136:139], v[12:15]
    v_pk_mul_f32 v[78:79], v[78:79], s[44:45]
    v_cvt_pk_bf16_f32 v72, v72, v73
    s_waitcnt lgkmcnt(4)
    v_mfma_f32_16x16x32_bf16 v[8:11], v[216:219], v[152:155], v[8:11]
    ds_read_b64_tr_b16 v[208:209], v178 offset:51200
    v_cvt_pk_bf16_f32 v73, v74, v75
    v_cvt_pk_bf16_f32 v74, v76, v77
    v_mfma_f32_16x16x32_bf16 v[32:35], v[216:219], v[156:159], v[32:35]
    ds_read_b64_tr_b16 v[210:211], v178 offset:51712
    v_cvt_pk_bf16_f32 v75, v78, v79
    buffer_store_dwordx4 v[72:75], v192, s[20:23], s42 offen offset:2304 sc1
    v_mfma_f32_16x16x32_bf16 v[56:59], v[216:219], v[160:163], v[56:59]
    ds_read_b64_tr_b16 v[212:213], v179 offset:51200
    v_pk_mul_f32 v[48:49], v[48:49], s[44:45]
    v_mfma_f32_16x16x32_bf16 v[80:83], v[216:219], v[164:167], v[80:83]
    ds_read_b64_tr_b16 v[214:215], v179 offset:51712
    v_pk_mul_f32 v[50:51], v[50:51], s[44:45]
    v_pk_mul_f32 v[52:53], v[52:53], s[44:45]
    v_mfma_f32_16x16x32_bf16 v[84:87], v[220:223], v[164:167], v[84:87]
    v_pk_mul_f32 v[54:55], v[54:55], s[44:45]
    v_cvt_pk_bf16_f32 v48, v48, v49
    v_mfma_f32_16x16x32_bf16 v[60:63], v[220:223], v[160:163], v[60:63]
    v_cvt_pk_bf16_f32 v49, v50, v51
    v_cvt_pk_bf16_f32 v50, v52, v53
    v_mfma_f32_16x16x32_bf16 v[36:39], v[220:223], v[156:159], v[36:39]
    v_cvt_pk_bf16_f32 v51, v54, v55
    buffer_store_dwordx4 v[48:51], v192, s[20:23], s42 offen offset:2048 sc1
    v_mfma_f32_16x16x32_bf16 v[12:15], v[220:223], v[152:155], v[12:15]
    v_pk_mul_f32 v[24:25], v[24:25], s[44:45]
    s_waitcnt lgkmcnt(4)
    v_mfma_f32_16x16x32_bf16 v[16:19], v[96:99], v[128:131], v[16:19]
    ds_read_b64_tr_b16 v[168:169], v178 offset:2048
    v_pk_mul_f32 v[26:27], v[26:27], s[44:45]
    v_pk_mul_f32 v[28:29], v[28:29], s[44:45]
    v_mfma_f32_16x16x32_bf16 v[40:43], v[100:103], v[128:131], v[40:43]
    ds_read_b64_tr_b16 v[170:171], v178 offset:2560
    v_pk_mul_f32 v[30:31], v[30:31], s[44:45]
    v_cvt_pk_bf16_f32 v24, v24, v25
    v_mfma_f32_16x16x32_bf16 v[64:67], v[104:107], v[128:131], v[64:67]
    ds_read_b64_tr_b16 v[172:173], v179 offset:2048
    v_cvt_pk_bf16_f32 v25, v26, v27
    v_cvt_pk_bf16_f32 v26, v28, v29
    v_mfma_f32_16x16x32_bf16 v[88:91], v[108:111], v[128:131], v[88:91]
    ds_read_b64_tr_b16 v[174:175], v179 offset:2560
    v_cvt_pk_bf16_f32 v27, v30, v31
    buffer_store_dwordx4 v[24:27], v192, s[20:23], s42 offen offset:256 sc1
    v_mfma_f32_16x16x32_bf16 v[92:95], v[108:111], v[132:135], v[92:95]
    v_pk_mul_f32 v[0:1], v[0:1], s[44:45]
    v_mfma_f32_16x16x32_bf16 v[68:71], v[104:107], v[132:135], v[68:71]
    v_pk_mul_f32 v[2:3], v[2:3], s[44:45]
    v_pk_mul_f32 v[4:5], v[4:5], s[44:45]
    v_mfma_f32_16x16x32_bf16 v[44:47], v[100:103], v[132:135], v[44:47]
    v_pk_mul_f32 v[6:7], v[6:7], s[44:45]
    v_cvt_pk_bf16_f32 v0, v0, v1
    v_mfma_f32_16x16x32_bf16 v[20:23], v[96:99], v[132:135], v[20:23]
    v_cvt_pk_bf16_f32 v1, v2, v3
    v_cvt_pk_bf16_f32 v2, v4, v5
    s_waitcnt lgkmcnt(4)
    v_mfma_f32_16x16x32_bf16 v[16:19], v[112:115], v[208:211], v[16:19]
    ds_read_b64_tr_b16 v[216:217], v178 offset:14336
    v_cvt_pk_bf16_f32 v3, v6, v7
    buffer_store_dwordx4 v[0:3], v192, s[20:23], s42 offen offset:0 sc1
    v_mfma_f32_16x16x32_bf16 v[40:43], v[116:119], v[208:211], v[40:43]
    ds_read_b64_tr_b16 v[218:219], v178 offset:14848
    v_mfma_f32_16x16x32_bf16 v[64:67], v[120:123], v[208:211], v[64:67]
    ds_read_b64_tr_b16 v[220:221], v179 offset:14336
    v_cvt_pk_bf16_f32 v80, v80, v81
    v_mfma_f32_16x16x32_bf16 v[88:91], v[124:127], v[208:211], v[88:91]
    ds_read_b64_tr_b16 v[222:223], v179 offset:14848
    v_cvt_pk_bf16_f32 v81, v82, v83
    v_mfma_f32_16x16x32_bf16 v[92:95], v[124:127], v[212:215], v[92:95]
    v_cvt_pk_bf16_f32 v82, v84, v85
    v_mfma_f32_16x16x32_bf16 v[68:71], v[120:123], v[212:215], v[68:71]
    v_cvt_pk_bf16_f32 v83, v86, v87
    v_mfma_f32_16x16x32_bf16 v[44:47], v[116:119], v[212:215], v[44:47]
    buffer_store_dwordx4 v[80:83], v193, s[20:23], s54 offen offset:128 sc1
    v_mfma_f32_16x16x32_bf16 v[20:23], v[112:115], v[212:215], v[20:23]
    v_cvt_pk_bf16_f32 v56, v56, v57
    s_waitcnt lgkmcnt(4)
    v_mfma_f32_16x16x32_bf16 v[16:19], v[136:139], v[168:171], v[16:19]
    v_mfma_f32_16x16x32_bf16 v[40:43], v[140:143], v[168:171], v[40:43]
    v_cvt_pk_bf16_f32 v57, v58, v59
    v_mfma_f32_16x16x32_bf16 v[64:67], v[144:147], v[168:171], v[64:67]
    v_cvt_pk_bf16_f32 v58, v60, v61
    v_mfma_f32_16x16x32_bf16 v[88:91], v[148:151], v[168:171], v[88:91]
    v_cvt_pk_bf16_f32 v59, v62, v63
    v_mfma_f32_16x16x32_bf16 v[92:95], v[148:151], v[172:175], v[92:95]
    buffer_store_dwordx4 v[56:59], v193, s[20:23], s54 offen offset:0 sc1
    v_mfma_f32_16x16x32_bf16 v[68:71], v[144:147], v[172:175], v[68:71]
    v_cvt_pk_bf16_f32 v32, v32, v33
    v_mfma_f32_16x16x32_bf16 v[44:47], v[140:143], v[172:175], v[44:47]
    v_cvt_pk_bf16_f32 v33, v34, v35
    v_mfma_f32_16x16x32_bf16 v[20:23], v[136:139], v[172:175], v[20:23]
    v_cvt_pk_bf16_f32 v34, v36, v37
    s_waitcnt lgkmcnt(0)
    v_mfma_f32_16x16x32_bf16 v[16:19], v[152:155], v[216:219], v[16:19]
    v_mfma_f32_16x16x32_bf16 v[40:43], v[156:159], v[216:219], v[40:43]
    v_cvt_pk_bf16_f32 v35, v38, v39
    v_mfma_f32_16x16x32_bf16 v[64:67], v[160:163], v[216:219], v[64:67]
    buffer_store_dwordx4 v[32:35], v193, s[20:23], s43 offen offset:128 sc1
    v_mfma_f32_16x16x32_bf16 v[88:91], v[164:167], v[216:219], v[88:91]
    v_cvt_pk_bf16_f32 v8, v8, v9
    v_mfma_f32_16x16x32_bf16 v[92:95], v[164:167], v[220:223], v[92:95]
    v_cvt_pk_bf16_f32 v9, v10, v11
    v_mfma_f32_16x16x32_bf16 v[68:71], v[160:163], v[220:223], v[68:71]
    v_cvt_pk_bf16_f32 v10, v12, v13
    v_mfma_f32_16x16x32_bf16 v[44:47], v[156:159], v[220:223], v[44:47]
    v_cvt_pk_bf16_f32 v11, v14, v15
    v_mfma_f32_16x16x32_bf16 v[20:23], v[152:155], v[220:223], v[20:23]
    buffer_store_dwordx4 v[8:11], v193, s[20:23], s43 offen offset:0 sc1
    s_nop 3
    v_cvt_pk_bf16_f32 v16, v16, v17
    v_cvt_pk_bf16_f32 v17, v18, v19
    v_cvt_pk_bf16_f32 v18, v40, v41
    v_cvt_pk_bf16_f32 v19, v42, v43
    buffer_store_dwordx4 v[16:19], v192, s[20:23], s43 offen offset:2048 sc1
    v_mfma_f32_16x16x32_bf16 v[224:227], v[8:11], v[0:3], 0
    v_mfma_f32_16x16x32_bf16 v[228:231], v[32:35], v[24:27], 0
    v_mfma_f32_16x16x32_bf16 v[232:235], v[56:59], v[48:51], 0
    v_mfma_f32_16x16x32_bf16 v[236:239], v[80:83], v[72:75], 0
    v_cvt_pk_bf16_f32 v64, v64, v65
    v_cvt_pk_bf16_f32 v65, v66, v67
    v_cvt_pk_bf16_f32 v66, v88, v89
    v_cvt_pk_bf16_f32 v67, v90, v91
    buffer_store_dwordx4 v[64:67], v192, s[20:23], s54 offen offset:2048 sc1
    v_cvt_pk_bf16_f32 v68, v68, v69
    v_cvt_pk_bf16_f32 v69, v70, v71
    v_cvt_pk_bf16_f32 v70, v92, v93
    v_cvt_pk_bf16_f32 v71, v94, v95
    buffer_store_dwordx4 v[68:71], v192, s[20:23], s54 offen offset:2304 sc1
    v_cvt_pk_bf16_f32 v20, v20, v21
    v_cvt_pk_bf16_f32 v21, v22, v23
    v_cvt_pk_bf16_f32 v22, v44, v45
    v_cvt_pk_bf16_f32 v23, v46, v47
    buffer_store_dwordx4 v[20:23], v192, s[20:23], s43 offen offset:2304 sc1
    v_max3_f32 v224, v224, v225, v226
    v_max_f32 v224, v224, v227
    v_max3_f32 v228, v228, v229, v230
    v_max_f32 v228, v228, v231
    v_max3_f32 v232, v232, v233, v234
    v_max_f32 v232, v232, v235
    v_max3_f32 v236, v236, v237, v238
    v_max_f32 v236, v236, v239
    s_lshr_b32 s39, s42, 4
    s_add_u32 s39, s39, 27000832
    v_permlane32_swap_b32 v224, v232
    v_permlane32_swap_b32 v228, v236
    v_max_f32 v224, v224, v232
    v_max_f32 v228, v228, v236
    v_lshrrev_b32 v189, 2, v187
    s_nop 0
    v_permlane16_swap_b32 v224, v228
    v_max_f32 v224, v224, v228
    v_sub_f32 v224, 0xc1c00000, v224
    buffer_store_dword v224, v189, s[20:23], s39 offen sc1
    s_branch L_fuse
L_qkv_epi_0:
    v_mov_b32 v196, 0x3f803f80
    v_mov_b32 v197, 0x3f803f80
    v_mov_b32 v198, 0x3f803f80
    v_mov_b32 v199, 0x3f803f80
    v_subrev_u32 v178, 36864, v178
    v_subrev_u32 v179, 36864, v179
    v_subrev_u32 v204, 65536, v176
    v_subrev_u32 v205, 65536, v177
    v_mfma_f32_16x16x32_bf16 v[92:95], v[108:111], v[132:135], v[92:95]
    v_mfma_f32_16x16x32_bf16 v[68:71], v[104:107], v[132:135], v[68:71]
    v_mfma_f32_16x16x32_bf16 v[44:47], v[100:103], v[132:135], v[44:47]
    v_mfma_f32_16x16x32_bf16 v[20:23], v[96:99], v[132:135], v[20:23]
    s_waitcnt vmcnt(3) lgkmcnt(0)
    s_barrier
    v_mfma_f32_16x16x32_bf16 v[0:3], v[152:155], v[136:139], v[0:3]
    s_cmp_ge_u32 s27, 4
    s_cbranch_scc1 L_qkv_t1_0
    s_mov_b32 m0, s30
    s_nop 0
    buffer_load_dwordx4 v180, s[12:15], s28 offen offset:0 lds
    buffer_load_dwordx4 v181, s[12:15], s28 offen offset:1024 lds
    buffer_load_dwordx4 v182, s[12:15], s28 offen offset:2048 lds
    buffer_load_dwordx4 v183, s[12:15], s28 offen offset:3072 lds
    s_branch L_qkv_t2_0
L_qkv_t1_0:
    s_mov_b32 m0, s31
    s_nop 0
    buffer_load_dwordx4 v184, s[16:19], s29 offen offset:0 lds
    buffer_load_dwordx4 v185, s[16:19], s29 offen offset:1024 lds
    buffer_load_dwordx4 v186, s[16:19], s29 offen offset:2048 lds
L_qkv_t2_0:
    ds_read_b64_tr_b16 v[128:129], v178 offset:37888
    v_mfma_f32_16x16x32_bf16 v[24:27], v[152:155], v[140:143], v[24:27]
    ds_read_b64_tr_b16 v[130:131], v178 offset:38400
    v_mfma_f32_16x16x32_bf16 v[48:51], v[152:155], v[144:147], v[48:51]
    ds_read_b64_tr_b16 v[132:133], v179 offset:37888
    v_mfma_f32_16x16x32_bf16 v[72:75], v[152:155], v[148:151], v[72:75]
    ds_read_b64_tr_b16 v[134:135], v179 offset:38400
    v_mfma_f32_16x16x32_bf16 v[76:79], v[156:159], v[148:151], v[76:79]
    ds_read_b128 v[96:99], v176 offset:0
    v_mfma_f32_16x16x32_bf16 v[52:55], v[156:159], v[144:147], v[52:55]
    ds_read_b128 v[100:103], v176 offset:2048
    v_mfma_f32_16x16x32_bf16 v[28:31], v[156:159], v[140:143], v[28:31]
    ds_read_b128 v[104:107], v176 offset:4096
    v_mfma_f32_16x16x32_bf16 v[4:7], v[156:159], v[136:139], v[4:7]
    ds_read_b128 v[108:111], v176 offset:6144
    v_mfma_f32_16x16x32_bf16 v[8:11], v[136:139], v[160:163], v[8:11]
    ds_read_b64_tr_b16 v[208:209], v178 offset:50176
    v_mfma_f32_16x16x32_bf16 v[32:35], v[140:143], v[160:163], v[32:35]
    ds_read_b64_tr_b16 v[210:211], v178 offset:50688
    v_mfma_f32_16x16x32_bf16 v[56:59], v[144:147], v[160:163], v[56:59]
    ds_read_b64_tr_b16 v[212:213], v179 offset:50176
    v_mfma_f32_16x16x32_bf16 v[80:83], v[148:151], v[160:163], v[80:83]
    ds_read_b64_tr_b16 v[214:215], v179 offset:50688
    v_mfma_f32_16x16x32_bf16 v[84:87], v[148:151], v[164:167], v[84:87]
    ds_read_b128 v[112:115], v177 offset:0
    v_mfma_f32_16x16x32_bf16 v[60:63], v[144:147], v[164:167], v[60:63]
    ds_read_b128 v[116:119], v177 offset:2048
    v_mfma_f32_16x16x32_bf16 v[36:39], v[140:143], v[164:167], v[36:39]
    ds_read_b128 v[120:123], v177 offset:4096
    v_mfma_f32_16x16x32_bf16 v[12:15], v[136:139], v[164:167], v[12:15]
    ds_read_b128 v[124:127], v177 offset:6144
    v_mfma_f32_16x16x32_bf16 v[16:19], v[136:139], v[168:171], v[16:19]
    v_mfma_f32_16x16x32_bf16 v[40:43], v[140:143], v[168:171], v[40:43]
    v_mfma_f32_16x16x32_bf16 v[64:67], v[144:147], v[168:171], v[64:67]
    v_mfma_f32_16x16x32_bf16 v[88:91], v[148:151], v[168:171], v[88:91]
    v_mfma_f32_16x16x32_bf16 v[92:95], v[148:151], v[172:175], v[92:95]
    v_mfma_f32_16x16x32_bf16 v[68:71], v[144:147], v[172:175], v[68:71]
    v_mfma_f32_16x16x32_bf16 v[44:47], v[140:143], v[172:175], v[44:47]
    v_mfma_f32_16x16x32_bf16 v[20:23], v[136:139], v[172:175], v[20:23]
    s_waitcnt lgkmcnt(0)
    v_mfma_f32_16x16x32_bf16 v[8:11], v[96:99], v[128:131], v[8:11]
    ds_read_b64_tr_b16 v[168:169], v178 offset:38912
    v_mfma_f32_16x16x32_bf16 v[32:35], v[100:103], v[128:131], v[32:35]
    ds_read_b64_tr_b16 v[170:171], v178 offset:39424
    v_mfma_f32_16x16x32_bf16 v[56:59], v[104:107], v[128:131], v[56:59]
    ds_read_b64_tr_b16 v[172:173], v179 offset:38912
    v_mfma_f32_16x16x32_bf16 v[80:83], v[108:111], v[128:131], v[80:83]
    ds_read_b64_tr_b16 v[174:175], v179 offset:39424
    v_mfma_f32_16x16x32_bf16 v[84:87], v[108:111], v[132:135], v[84:87]
    v_mfma_f32_16x16x32_bf16 v[60:63], v[104:107], v[132:135], v[60:63]
    v_mfma_f32_16x16x32_bf16 v[36:39], v[100:103], v[132:135], v[36:39]
    v_mfma_f32_16x16x32_bf16 v[12:15], v[96:99], v[132:135], v[12:15]
    s_waitcnt lgkmcnt(4)
    v_mfma_f32_16x16x32_bf16 v[8:11], v[112:115], v[208:211], v[8:11]
    ds_read_b64_tr_b16 v[216:217], v178 offset:51200
    v_mfma_f32_16x16x32_bf16 v[32:35], v[116:119], v[208:211], v[32:35]
    ds_read_b64_tr_b16 v[218:219], v178 offset:51712
    v_mfma_f32_16x16x32_bf16 v[56:59], v[120:123], v[208:211], v[56:59]
    ds_read_b64_tr_b16 v[220:221], v179 offset:51200
    v_mfma_f32_16x16x32_bf16 v[80:83], v[124:127], v[208:211], v[80:83]
    ds_read_b64_tr_b16 v[222:223], v179 offset:51712
    v_mfma_f32_16x16x32_bf16 v[84:87], v[124:127], v[212:215], v[84:87]
    v_mfma_f32_16x16x32_bf16 v[60:63], v[120:123], v[212:215], v[60:63]
    v_mfma_f32_16x16x32_bf16 v[36:39], v[116:119], v[212:215], v[36:39]
    v_mfma_f32_16x16x32_bf16 v[12:15], v[112:115], v[212:215], v[12:15]
    s_waitcnt vmcnt(0) lgkmcnt(4)
    s_barrier
    v_readfirstlane_b32 s82, v203
    v_mfma_f32_16x16x32_bf16 v[16:19], v[96:99], v[168:171], v[16:19]
    ds_read_b64_tr_b16 v[128:129], v178 offset:1024
    v_mfma_f32_16x16x32_bf16 v[40:43], v[100:103], v[168:171], v[40:43]
    ds_read_b64_tr_b16 v[130:131], v178 offset:1536
    v_mfma_f32_16x16x32_bf16 v[64:67], v[104:107], v[168:171], v[64:67]
    ds_read_b64_tr_b16 v[132:133], v179 offset:1024
    v_mfma_f32_16x16x32_bf16 v[88:91], v[108:111], v[168:171], v[88:91]
    ds_read_b64_tr_b16 v[134:135], v179 offset:1536
    v_mfma_f32_16x16x32_bf16 v[92:95], v[108:111], v[172:175], v[92:95]
    ds_read_b128 v[136:139], v204 offset:0
    v_mfma_f32_16x16x32_bf16 v[68:71], v[104:107], v[172:175], v[68:71]
    ds_read_b128 v[140:143], v204 offset:2048
    v_mfma_f32_16x16x32_bf16 v[44:47], v[100:103], v[172:175], v[44:47]
    ds_read_b128 v[144:147], v204 offset:4096
    v_mfma_f32_16x16x32_bf16 v[20:23], v[96:99], v[172:175], v[20:23]
    ds_read_b128 v[148:151], v204 offset:6144
    s_waitcnt lgkmcnt(8)
    v_mfma_f32_16x16x32_bf16 v[16:19], v[112:115], v[216:219], v[16:19]
    ds_read_b64_tr_b16 v[208:209], v178 offset:13312
    v_mfma_f32_16x16x32_bf16 v[40:43], v[116:119], v[216:219], v[40:43]
    ds_read_b64_tr_b16 v[210:211], v178 offset:13824
    v_mfma_f32_16x16x32_bf16 v[64:67], v[120:123], v[216:219], v[64:67]
    ds_read_b64_tr_b16 v[212:213], v179 offset:13312
    v_mfma_f32_16x16x32_bf16 v[88:91], v[124:127], v[216:219], v[88:91]
    ds_read_b64_tr_b16 v[214:215], v179 offset:13824
    v_mfma_f32_16x16x32_bf16 v[92:95], v[124:127], v[220:223], v[92:95]
    ds_read_b128 v[152:155], v205 offset:0
    v_mfma_f32_16x16x32_bf16 v[68:71], v[120:123], v[220:223], v[68:71]
    ds_read_b128 v[156:159], v205 offset:2048
    v_mfma_f32_16x16x32_bf16 v[44:47], v[116:119], v[220:223], v[44:47]
    ds_read_b128 v[160:163], v205 offset:4096
    v_mfma_f32_16x16x32_bf16 v[20:23], v[112:115], v[220:223], v[20:23]
    ds_read_b128 v[164:167], v205 offset:6144
    s_waitcnt lgkmcnt(8)
    v_mfma_f32_16x16x32_bf16 v[8:11], v[136:139], v[128:131], v[8:11]
    ds_read_b64_tr_b16 v[168:169], v178 offset:2048
    v_mfma_f32_16x16x32_bf16 v[32:35], v[140:143], v[128:131], v[32:35]
    ds_read_b64_tr_b16 v[170:171], v178 offset:2560
    v_mfma_f32_16x16x32_bf16 v[56:59], v[144:147], v[128:131], v[56:59]
    ds_read_b64_tr_b16 v[172:173], v179 offset:2048
    v_mfma_f32_16x16x32_bf16 v[80:83], v[148:151], v[128:131], v[80:83]
    ds_read_b64_tr_b16 v[174:175], v179 offset:2560
    v_mfma_f32_16x16x32_bf16 v[84:87], v[148:151], v[132:135], v[84:87]
    v_mfma_f32_16x16x32_bf16 v[60:63], v[144:147], v[132:135], v[60:63]
    v_mfma_f32_16x16x32_bf16 v[36:39], v[140:143], v[132:135], v[36:39]
    v_mfma_f32_16x16x32_bf16 v[12:15], v[136:139], v[132:135], v[12:15]
    s_waitcnt lgkmcnt(4)
    v_mfma_f32_16x16x32_bf16 v[8:11], v[152:155], v[208:211], v[8:11]
    ds_read_b64_tr_b16 v[216:217], v178 offset:14336
    v_mfma_f32_16x16x32_bf16 v[32:35], v[156:159], v[208:211], v[32:35]
    ds_read_b64_tr_b16 v[218:219], v178 offset:14848
    v_mfma_f32_16x16x32_bf16 v[56:59], v[160:163], v[208:211], v[56:59]
    ds_read_b64_tr_b16 v[220:221], v179 offset:14336
    v_mfma_f32_16x16x32_bf16 v[80:83], v[164:167], v[208:211], v[80:83]
    ds_read_b64_tr_b16 v[222:223], v179 offset:14848
    v_mfma_f32_16x16x32_bf16 v[84:87], v[164:167], v[212:215], v[84:87]
    v_mfma_f32_16x16x32_bf16 v[60:63], v[160:163], v[212:215], v[60:63]
    v_mfma_f32_16x16x32_bf16 v[36:39], v[156:159], v[212:215], v[36:39]
    v_mfma_f32_16x16x32_bf16 v[12:15], v[152:155], v[212:215], v[12:15]
    s_waitcnt lgkmcnt(4)
    v_mfma_f32_16x16x32_bf16 v[16:19], v[136:139], v[168:171], v[16:19]
    ds_read_b64_tr_b16 v[128:129], v178 offset:36864
    v_mfma_f32_16x16x32_bf16 v[40:43], v[140:143], v[168:171], v[40:43]
    ds_read_b64_tr_b16 v[130:131], v178 offset:37376
    v_mfma_f32_16x16x32_bf16 v[64:67], v[144:147], v[168:171], v[64:67]
    ds_read_b64_tr_b16 v[132:133], v179 offset:36864
    v_mfma_f32_16x16x32_bf16 v[88:91], v[148:151], v[168:171], v[88:91]
    ds_read_b64_tr_b16 v[134:135], v179 offset:37376
    v_mfma_f32_16x16x32_bf16 v[92:95], v[148:151], v[172:175], v[92:95]
    v_mfma_f32_16x16x32_bf16 v[68:71], v[144:147], v[172:175], v[68:71]
    v_pk_fma_f32 v[224:225], v[80:81], s[44:45], v[194:195]
    v_pk_fma_f32 v[226:227], v[82:83], s[44:45], v[194:195]
    v_mfma_f32_16x16x32_bf16 v[44:47], v[140:143], v[172:175], v[44:47]
    v_pk_fma_f32 v[228:229], v[84:85], s[44:45], v[194:195]
    v_pk_fma_f32 v[230:231], v[86:87], s[44:45], v[194:195]
    v_exp_f32_e64 v224, v224 clamp
    v_mfma_f32_16x16x32_bf16 v[20:23], v[136:139], v[172:175], v[20:23]
    v_exp_f32_e64 v225, v225 clamp
    v_exp_f32_e64 v226, v226 clamp
    v_exp_f32_e64 v227, v227 clamp
    s_waitcnt lgkmcnt(4)
    v_mfma_f32_16x16x32_bf16 v[16:19], v[152:155], v[216:219], v[16:19]
    ds_read_b64_tr_b16 v[208:209], v178 offset:49152
    v_exp_f32_e64 v228, v228 clamp
    v_exp_f32_e64 v229, v229 clamp
    v_exp_f32_e64 v230, v230 clamp
    v_mfma_f32_16x16x32_bf16 v[40:43], v[156:159], v[216:219], v[40:43]
    ds_read_b64_tr_b16 v[210:211], v178 offset:49664
    v_exp_f32_e64 v231, v231 clamp
    v_max_f32 v80, s55, v80
    v_max_f32 v81, s55, v81
    v_mfma_f32_16x16x32_bf16 v[64:67], v[160:163], v[216:219], v[64:67]
    ds_read_b64_tr_b16 v[212:213], v179 offset:49152
    v_max_f32 v82, s55, v82
    v_max_f32 v83, s55, v83
    v_max_f32 v84, s55, v84
    v_mfma_f32_16x16x32_bf16 v[88:91], v[164:167], v[216:219], v[88:91]
    ds_read_b64_tr_b16 v[214:215], v179 offset:49664
    v_max_f32 v85, s55, v85
    v_max_f32 v86, s55, v86
    v_max_f32 v87, s55, v87
    v_mfma_f32_16x16x32_bf16 v[92:95], v[164:167], v[220:223], v[92:95]
    v_pk_add_f32 v[80:81], v[80:81], v[224:225]
    v_pk_add_f32 v[82:83], v[82:83], v[226:227]
    v_pk_add_f32 v[84:85], v[84:85], v[228:229]
    v_mfma_f32_16x16x32_bf16 v[68:71], v[160:163], v[220:223], v[68:71]
    v_pk_add_f32 v[86:87], v[86:87], v[230:231]
    v_pk_fma_f32 v[224:225], v[56:57], s[44:45], v[194:195]
    v_pk_fma_f32 v[226:227], v[58:59], s[44:45], v[194:195]
    v_mfma_f32_16x16x32_bf16 v[44:47], v[156:159], v[220:223], v[44:47]
    v_pk_fma_f32 v[228:229], v[60:61], s[44:45], v[194:195]
    v_pk_fma_f32 v[230:231], v[62:63], s[44:45], v[194:195]
    v_exp_f32_e64 v224, v224 clamp
    v_mfma_f32_16x16x32_bf16 v[20:23], v[152:155], v[220:223], v[20:23]
    v_exp_f32_e64 v225, v225 clamp
    v_exp_f32_e64 v226, v226 clamp
    v_exp_f32_e64 v227, v227 clamp
    s_waitcnt lgkmcnt(4)
    v_mfma_f32_16x16x32_bf16 v[0:3], v[128:131], v[96:99], v[0:3]
    ds_read_b64_tr_b16 v[168:169], v178 offset:0
    v_exp_f32_e64 v228, v228 clamp
    v_exp_f32_e64 v229, v229 clamp
    v_exp_f32_e64 v230, v230 clamp
    v_mfma_f32_16x16x32_bf16 v[24:27], v[128:131], v[100:103], v[24:27]
    ds_read_b64_tr_b16 v[170:171], v178 offset:512
    v_exp_f32_e64 v231, v231 clamp
    v_max_f32 v56, s55, v56
    v_max_f32 v57, s55, v57
    v_mfma_f32_16x16x32_bf16 v[48:51], v[128:131], v[104:107], v[48:51]
    ds_read_b64_tr_b16 v[172:173], v179 offset:0
    v_max_f32 v58, s55, v58
    v_max_f32 v59, s55, v59
    v_max_f32 v60, s55, v60
    v_mfma_f32_16x16x32_bf16 v[72:75], v[128:131], v[108:111], v[72:75]
    ds_read_b64_tr_b16 v[174:175], v179 offset:512
    v_max_f32 v61, s55, v61
    v_max_f32 v62, s55, v62
    v_max_f32 v63, s55, v63
    v_mfma_f32_16x16x32_bf16 v[76:79], v[132:135], v[108:111], v[76:79]
    v_pk_add_f32 v[56:57], v[56:57], v[224:225]
    v_pk_add_f32 v[58:59], v[58:59], v[226:227]
    v_pk_add_f32 v[60:61], v[60:61], v[228:229]
    v_mfma_f32_16x16x32_bf16 v[52:55], v[132:135], v[104:107], v[52:55]
    v_pk_add_f32 v[62:63], v[62:63], v[230:231]
    v_pk_fma_f32 v[224:225], v[32:33], s[44:45], v[194:195]
    v_pk_fma_f32 v[226:227], v[34:35], s[44:45], v[194:195]
    v_mfma_f32_16x16x32_bf16 v[28:31], v[132:135], v[100:103], v[28:31]
    v_pk_fma_f32 v[228:229], v[36:37], s[44:45], v[194:195]
    v_pk_fma_f32 v[230:231], v[38:39], s[44:45], v[194:195]
    v_exp_f32_e64 v224, v224 clamp
    v_mfma_f32_16x16x32_bf16 v[4:7], v[132:135], v[96:99], v[4:7]
    v_exp_f32_e64 v225, v225 clamp
    v_exp_f32_e64 v226, v226 clamp
    v_exp_f32_e64 v227, v227 clamp
    s_waitcnt lgkmcnt(4)
    v_mfma_f32_16x16x32_bf16 v[0:3], v[208:211], v[112:115], v[0:3]
    ds_read_b64_tr_b16 v[216:217], v178 offset:12288
    v_exp_f32_e64 v228, v228 clamp
    v_exp_f32_e64 v229, v229 clamp
    v_exp_f32_e64 v230, v230 clamp
    v_mfma_f32_16x16x32_bf16 v[24:27], v[208:211], v[116:119], v[24:27]
    ds_read_b64_tr_b16 v[218:219], v178 offset:12800
    v_exp_f32_e64 v231, v231 clamp
    v_max_f32 v32, s55, v32
    v_max_f32 v33, s55, v33
    v_mfma_f32_16x16x32_bf16 v[48:51], v[208:211], v[120:123], v[48:51]
    ds_read_b64_tr_b16 v[220:221], v179 offset:12288
    v_max_f32 v34, s55, v34
    v_max_f32 v35, s55, v35
    v_max_f32 v36, s55, v36
    v_mfma_f32_16x16x32_bf16 v[72:75], v[208:211], v[124:127], v[72:75]
    ds_read_b64_tr_b16 v[222:223], v179 offset:12800
    v_max_f32 v37, s55, v37
    v_max_f32 v38, s55, v38
    v_max_f32 v39, s55, v39
    v_mfma_f32_16x16x32_bf16 v[76:79], v[212:215], v[124:127], v[76:79]
    v_pk_add_f32 v[32:33], v[32:33], v[224:225]
    v_pk_add_f32 v[34:35], v[34:35], v[226:227]
    v_pk_add_f32 v[36:37], v[36:37], v[228:229]
    v_mfma_f32_16x16x32_bf16 v[52:55], v[212:215], v[120:123], v[52:55]
    v_pk_add_f32 v[38:39], v[38:39], v[230:231]
    v_pk_fma_f32 v[224:225], v[8:9], s[44:45], v[194:195]
    v_pk_fma_f32 v[226:227], v[10:11], s[44:45], v[194:195]
    v_mfma_f32_16x16x32_bf16 v[28:31], v[212:215], v[116:119], v[28:31]
    v_pk_fma_f32 v[228:229], v[12:13], s[44:45], v[194:195]
    v_pk_fma_f32 v[230:231], v[14:15], s[44:45], v[194:195]
    v_exp_f32_e64 v224, v224 clamp
    v_mfma_f32_16x16x32_bf16 v[4:7], v[212:215], v[112:115], v[4:7]
    v_exp_f32_e64 v225, v225 clamp
    v_exp_f32_e64 v226, v226 clamp
    v_exp_f32_e64 v227, v227 clamp
    s_waitcnt lgkmcnt(4)
    v_mfma_f32_16x16x32_bf16 v[0:3], v[168:171], v[136:139], v[0:3]
    v_exp_f32_e64 v228, v228 clamp
    v_exp_f32_e64 v229, v229 clamp
    v_exp_f32_e64 v230, v230 clamp
    v_mfma_f32_16x16x32_bf16 v[24:27], v[168:171], v[140:143], v[24:27]
    v_exp_f32_e64 v231, v231 clamp
    v_max_f32 v8, s55, v8
    v_max_f32 v9, s55, v9
    v_mfma_f32_16x16x32_bf16 v[48:51], v[168:171], v[144:147], v[48:51]
    v_max_f32 v10, s55, v10
    v_max_f32 v11, s55, v11
    v_max_f32 v12, s55, v12
    v_mfma_f32_16x16x32_bf16 v[72:75], v[168:171], v[148:151], v[72:75]
    v_max_f32 v13, s55, v13
    v_max_f32 v14, s55, v14
    v_max_f32 v15, s55, v15
    v_mfma_f32_16x16x32_bf16 v[76:79], v[172:175], v[148:151], v[76:79]
    v_pk_add_f32 v[8:9], v[8:9], v[224:225]
    v_pk_add_f32 v[10:11], v[10:11], v[226:227]
    v_pk_add_f32 v[12:13], v[12:13], v[228:229]
    v_mfma_f32_16x16x32_bf16 v[52:55], v[172:175], v[144:147], v[52:55]
    v_pk_add_f32 v[14:15], v[14:15], v[230:231]
    v_cvt_pk_bf16_f32 v56, v56, v57
    v_cvt_pk_bf16_f32 v57, v58, v59
    v_mfma_f32_16x16x32_bf16 v[28:31], v[172:175], v[140:143], v[28:31]
    v_cvt_pk_bf16_f32 v58, v80, v81
    v_cvt_pk_bf16_f32 v59, v82, v83
    v_cvt_pk_bf16_f32 v60, v60, v61
    v_mfma_f32_16x16x32_bf16 v[4:7], v[172:175], v[136:139], v[4:7]
    v_cvt_pk_bf16_f32 v61, v62, v63
    v_cvt_pk_bf16_f32 v62, v84, v85
    v_cvt_pk_bf16_f32 v63, v86, v87
    s_waitcnt lgkmcnt(0)
    v_mfma_f32_16x16x32_bf16 v[0:3], v[216:219], v[152:155], v[0:3]
    v_cvt_pk_bf16_f32 v64, v64, v65
    v_cvt_pk_bf16_f32 v65, v66, v67
    v_cvt_pk_bf16_f32 v66, v88, v89
    v_mfma_f32_16x16x32_bf16 v[24:27], v[216:219], v[156:159], v[24:27]
    v_cvt_pk_bf16_f32 v67, v90, v91
    v_cvt_pk_bf16_f32 v68, v68, v69
    v_cvt_pk_bf16_f32 v69, v70, v71
    v_mfma_f32_16x16x32_bf16 v[48:51], v[216:219], v[160:163], v[48:51]
    v_cvt_pk_bf16_f32 v70, v92, v93
    v_cvt_pk_bf16_f32 v71, v94, v95
    v_cvt_pk_bf16_f32 v8, v8, v9
    v_mfma_f32_16x16x32_bf16 v[72:75], v[216:219], v[164:167], v[72:75]
    v_cvt_pk_bf16_f32 v9, v10, v11
    v_cvt_pk_bf16_f32 v10, v32, v33
    v_cvt_pk_bf16_f32 v11, v34, v35
    v_mfma_f32_16x16x32_bf16 v[76:79], v[220:223], v[164:167], v[76:79]
    v_cvt_pk_bf16_f32 v12, v12, v13
    v_cvt_pk_bf16_f32 v13, v14, v15
    v_cvt_pk_bf16_f32 v14, v36, v37
    v_mfma_f32_16x16x32_bf16 v[52:55], v[220:223], v[160:163], v[52:55]
    v_cvt_pk_bf16_f32 v15, v38, v39
    v_cvt_pk_bf16_f32 v16, v16, v17
    v_cvt_pk_bf16_f32 v17, v18, v19
    v_mfma_f32_16x16x32_bf16 v[28:31], v[220:223], v[156:159], v[28:31]
    v_cvt_pk_bf16_f32 v18, v40, v41
    v_cvt_pk_bf16_f32 v19, v42, v43
    v_cvt_pk_bf16_f32 v20, v20, v21
    v_mfma_f32_16x16x32_bf16 v[4:7], v[220:223], v[152:155], v[4:7]
    v_cvt_pk_bf16_f32 v21, v22, v23
    v_cvt_pk_bf16_f32 v22, v44, v45
    v_cvt_pk_bf16_f32 v23, v46, v47
    s_nop 1
    v_mfma_f32_16x16x32_bf16 v[232:235], v[56:59], v[64:67], 0
    v_mfma_f32_16x16x32_bf16 v[236:239], v[56:59], v[68:71], 0
    v_mfma_f32_16x16x32_bf16 v[248:251], v[56:59], v[196:199], 0
    v_mfma_f32_16x16x32_bf16 v[240:243], v[60:63], v[64:67], 0
    v_mfma_f32_16x16x32_bf16 v[244:247], v[60:63], v[68:71], 0
    v_mfma_f32_16x16x32_bf16 v[252:255], v[60:63], v[196:199], 0
    v_mfma_f32_16x16x32_bf16 v[232:235], v[8:11], v[16:19], v[232:235]
    v_mfma_f32_16x16x32_bf16 v[236:239], v[8:11], v[20:23], v[236:239]
    v_mfma_f32_16x16x32_bf16 v[248:251], v[8:11], v[196:199], v[248:251]
    v_mfma_f32_16x16x32_bf16 v[240:243], v[12:15], v[16:19], v[240:243]
    v_mfma_f32_16x16x32_bf16 v[244:247], v[12:15], v[20:23], v[244:247]
    v_mfma_f32_16x16x32_bf16 v[252:255], v[12:15], v[196:199], v[252:255]
    s_mov_b32 s86, s42
    v_pk_fma_f32 v[224:225], v[72:73], s[44:45], v[194:195]
    v_pk_fma_f32 v[226:227], v[74:75], s[44:45], v[194:195]
    v_pk_fma_f32 v[228:229], v[76:77], s[44:45], v[194:195]
    v_pk_fma_f32 v[230:231], v[78:79], s[44:45], v[194:195]
    v_exp_f32_e64 v224, v224 clamp
    v_exp_f32_e64 v225, v225 clamp
    v_exp_f32_e64 v226, v226 clamp
    v_exp_f32_e64 v227, v227 clamp
    v_exp_f32_e64 v228, v228 clamp
    v_exp_f32_e64 v229, v229 clamp
    v_exp_f32_e64 v230, v230 clamp
    v_exp_f32_e64 v231, v231 clamp
    v_max_f32 v72, s55, v72
    v_max_f32 v73, s55, v73
    v_max_f32 v74, s55, v74
    v_max_f32 v75, s55, v75
    v_max_f32 v76, s55, v76
    v_max_f32 v77, s55, v77
    v_max_f32 v78, s55, v78
    v_max_f32 v79, s55, v79
    v_pk_add_f32 v[72:73], v[72:73], v[224:225]
    v_pk_add_f32 v[74:75], v[74:75], v[226:227]
    v_pk_add_f32 v[76:77], v[76:77], v[228:229]
    v_pk_add_f32 v[78:79], v[78:79], v[230:231]
    v_cvt_pk_bf16_f32 v208, v72, v73
    v_cvt_pk_bf16_f32 v209, v74, v75
    v_cvt_pk_bf16_f32 v210, v76, v77
    v_cvt_pk_bf16_f32 v211, v78, v79
    v_and_b32 v189, 0x400, v192
    v_add_u32 v189, v189, v192
    s_lshl_b32 s41, s27, 12
    s_add_u32 s41, s41, 32768
    v_add_u32 v189, s41, v189
    ds_write_b128 v189, v[232:235] offset:0
    ds_write_b128 v189, v[236:239] offset:256
    ds_write_b128 v189, v[240:243] offset:1024
    ds_write_b128 v189, v[244:247] offset:1280
    v_lshrrev_b32 v190, 3, v192
    v_and_b32 v190, 64, v190
    v_lshrrev_b32 v191, 5, v192
    v_and_b32 v191, 32, v191
    v_add_u32 v190, v190, v191
    s_lshl_b32 s41, s27, 7
    s_add_u32 s41, s41, 122880
    v_add_u32 v190, s41, v190
    s_mov_b32 exec_lo, 0x00010001
    s_mov_b32 exec_hi, 0x00010001
    ds_write_b128 v190, v[248:251] offset:0
    ds_write_b128 v190, v[252:255] offset:16
    s_mov_b64 exec, -1
    v_pk_fma_f32 v[224:225], v[48:49], s[44:45], v[194:195]
    v_pk_fma_f32 v[226:227], v[50:51], s[44:45], v[194:195]
    v_pk_fma_f32 v[228:229], v[52:53], s[44:45], v[194:195]
    v_pk_fma_f32 v[230:231], v[54:55], s[44:45], v[194:195]
    v_exp_f32_e64 v224, v224 clamp
    v_exp_f32_e64 v225, v225 clamp
    v_exp_f32_e64 v226, v226 clamp
    v_exp_f32_e64 v227, v227 clamp
    v_exp_f32_e64 v228, v228 clamp
    v_exp_f32_e64 v229, v229 clamp
    v_exp_f32_e64 v230, v230 clamp
    v_exp_f32_e64 v231, v231 clamp
    v_max_f32 v48, s55, v48
    v_max_f32 v49, s55, v49
    v_max_f32 v50, s55, v50
    v_max_f32 v51, s55, v51
    v_max_f32 v52, s55, v52
    v_max_f32 v53, s55, v53
    v_max_f32 v54, s55, v54
    v_max_f32 v55, s55, v55
    v_pk_add_f32 v[48:49], v[48:49], v[224:225]
    v_pk_add_f32 v[50:51], v[50:51], v[226:227]
    v_pk_add_f32 v[52:53], v[52:53], v[228:229]
    v_pk_add_f32 v[54:55], v[54:55], v[230:231]
    v_cvt_pk_bf16_f32 v204, v48, v49
    v_cvt_pk_bf16_f32 v205, v50, v51
    v_cvt_pk_bf16_f32 v206, v52, v53
    v_cvt_pk_bf16_f32 v207, v54, v55
    v_pk_fma_f32 v[224:225], v[24:25], s[44:45], v[194:195]
    v_pk_fma_f32 v[226:227], v[26:27], s[44:45], v[194:195]
    v_pk_fma_f32 v[228:229], v[28:29], s[44:45], v[194:195]
    v_pk_fma_f32 v[230:231], v[30:31], s[44:45], v[194:195]
    v_exp_f32_e64 v224, v224 clamp
    v_exp_f32_e64 v225, v225 clamp
    v_exp_f32_e64 v226, v226 clamp
    v_exp_f32_e64 v227, v227 clamp
    v_exp_f32_e64 v228, v228 clamp
    v_exp_f32_e64 v229, v229 clamp
    v_exp_f32_e64 v230, v230 clamp
    v_exp_f32_e64 v231, v231 clamp
    v_max_f32 v24, s55, v24
    v_max_f32 v25, s55, v25
    v_max_f32 v26, s55, v26
    v_max_f32 v27, s55, v27
    v_max_f32 v28, s55, v28
    v_max_f32 v29, s55, v29
    v_max_f32 v30, s55, v30
    v_max_f32 v31, s55, v31
    v_pk_add_f32 v[24:25], v[24:25], v[224:225]
    v_pk_add_f32 v[26:27], v[26:27], v[226:227]
    v_pk_add_f32 v[28:29], v[28:29], v[228:229]
    v_pk_add_f32 v[30:31], v[30:31], v[230:231]
    v_cvt_pk_bf16_f32 v200, v24, v25
    v_cvt_pk_bf16_f32 v201, v26, v27
    v_cvt_pk_bf16_f32 v202, v28, v29
    v_cvt_pk_bf16_f32 v203, v30, v31
    s_waitcnt lgkmcnt(0)
    s_barrier
    s_and_b32 s39, s27, 1
    s_lshl_b32 s40, s39, 12
    s_lshr_b32 s41, s27, 1
    s_lshl_b32 s41, s41, 10
    s_add_u32 s40, s40, s41
    s_add_u32 s40, s40, 32768
    v_add_u32 v189, s40, v187
    ds_read_b128 v[136:139], v189 offset:0
    ds_read_b128 v[140:143], v189 offset:8192
    ds_read_b128 v[144:147], v189 offset:16384
    ds_read_b128 v[148:151], v189 offset:24576
    v_and_b32 v190, 0x70, v187
    s_lshl_b32 s40, s39, 7
    s_add_u32 s40, s40, 122880
    v_add_u32 v191, s40, v190
    ds_read_b128 v[152:155], v191 offset:0
    ds_read_b128 v[156:159], v191 offset:256
    ds_read_b128 v[160:163], v191 offset:512
    ds_read_b128 v[164:167], v191 offset:768
    v_pk_fma_f32 v[224:225], v[0:1], s[44:45], v[194:195]
    v_pk_fma_f32 v[226:227], v[2:3], s[44:45], v[194:195]
    v_pk_fma_f32 v[228:229], v[4:5], s[44:45], v[194:195]
    v_pk_fma_f32 v[230:231], v[6:7], s[44:45], v[194:195]
    v_exp_f32_e64 v224, v224 clamp
    v_exp_f32_e64 v225, v225 clamp
    v_exp_f32_e64 v226, v226 clamp
    v_exp_f32_e64 v227, v227 clamp
    v_exp_f32_e64 v228, v228 clamp
    v_exp_f32_e64 v229, v229 clamp
    v_exp_f32_e64 v230, v230 clamp
    v_exp_f32_e64 v231, v231 clamp
    v_max_f32 v0, s55, v0
    v_max_f32 v1, s55, v1
    v_max_f32 v2, s55, v2
    v_max_f32 v3, s55, v3
    v_max_f32 v4, s55, v4
    v_max_f32 v5, s55, v5
    v_max_f32 v6, s55, v6
    v_max_f32 v7, s55, v7
    v_pk_add_f32 v[0:1], v[0:1], v[224:225]
    v_pk_add_f32 v[2:3], v[2:3], v[226:227]
    v_pk_add_f32 v[4:5], v[4:5], v[228:229]
    v_pk_add_f32 v[6:7], v[6:7], v[230:231]
    v_cvt_pk_bf16_f32 v196, v0, v1
    v_cvt_pk_bf16_f32 v197, v2, v3
    v_cvt_pk_bf16_f32 v198, v4, v5
    v_cvt_pk_bf16_f32 v199, v6, v7
    s_waitcnt lgkmcnt(0)
    v_pk_add_f32 v[136:137], v[136:137], v[140:141]
    v_pk_add_f32 v[138:139], v[138:139], v[142:143]
    v_pk_add_f32 v[144:145], v[144:145], v[148:149]
    v_pk_add_f32 v[146:147], v[146:147], v[150:151]
    v_pk_add_f32 v[136:137], v[136:137], v[144:145]
    v_pk_add_f32 v[138:139], v[138:139], v[146:147]
    v_pk_add_f32 v[152:153], v[152:153], v[156:157]
    v_pk_add_f32 v[154:155], v[154:155], v[158:159]
    v_pk_add_f32 v[160:161], v[160:161], v[164:165]
    v_pk_add_f32 v[162:163], v[162:163], v[166:167]
    v_pk_add_f32 v[152:153], v[152:153], v[160:161]
    v_pk_add_f32 v[154:155], v[154:155], v[162:163]
    buffer_store_dwordx4 v[136:139], v187, s[20:23], s43 offen sc1
    s_cmp_ge_u32 s27, 2
    s_cbranch_scc1 L_fuse
    s_mov_b64 exec, 0xff
    buffer_store_dwordx4 v[152:155], v190, s[20:23], s54 offen sc1
    s_mov_b64 exec, -1
L_fuse:
    s_lshl_b32 s39, s27, 6
    s_mul_i32 s82, s82, 0x9e3779b1
    s_add_u32 s82, s82, 0x7f4a7c15
    v_lshrrev_b32 v0, 4, v187
    v_add_u32 v0, s39, v0
    s_and_b32 s52, s2, 7
    s_lshl_b32 s52, s52, 1
    s_lshr_b32 s53, s2, 7
    s_add_u32 s52, s52, s53
    s_lshl_b32 s52, s52, 10
    s_add_u32 s52, s52, 26804224
    v_and_b32 v233, 7, v0
    v_lshlrev_b32 v233, 7, v233
    s_add_u32 s53, s52, 16384
    v_mov_b32 v212, s82
    v_mov_b32 v213, s82
    v_mov_b32 v214, s82
    v_mov_b32 v215, s82
    s_cmp_lt_u32 s2, 128
    s_cbranch_scc1 L_at_pub0
    s_waitcnt vmcnt(0)
    s_barrier
    s_cmp_lg_u32 s27, 0
    s_cbranch_scc1 L_at_pub0
    s_mov_b64 exec, 0xff
    buffer_store_dwordx4 v[212:215], v187, s[20:23], s83 offen sc1
    s_mov_b64 exec, -1
L_at_pub0:
    s_cmp_lg_u32 s27, 1
    s_cbranch_scc1 L_at_pub1
    v_mov_b32 v216, s82
    s_mov_b64 exec, 0xff
    v_mov_b32 v216, 0
    buffer_atomic_add v216, v233, s[20:23], s53 offen sc0 sc1
    s_mov_b64 exec, -1
L_at_pub1:
    s_load_dwordx2 s[8:9], s[0:1], 64
    s_load_dwordx2 s[4:5], s[0:1], 16
    s_load_dwordx2 s[6:7], s[0:1], 40
    s_load_dwordx2 s[10:11], s[0:1], 48
    v_lshrrev_b32 v3, 6, v0
    s_and_b32 s26, s2, 7
    s_lshr_b32 s27, s2, 3
    v_readfirstlane_b32 s22, v3
    s_lshl_b32 s20, s26, 2
    s_lshr_b32 s28, s27, 3
    s_add_u32 s20, s20, s28
    s_and_b32 s21, s27, 7
    v_and_b32 v1, 63, v0
    v_lshlrev_b32 v1, 4, v1
    s_lshr_b32 s32, s22, 2
    s_lshl_b32 s40, s22, 12
    s_and_b32 s26, s22, 3
    s_lshl_b32 s27, s26, 12
    s_lshl_b32 s28, s32, 17
    s_add_u32 s27, s27, s28
    v_add_u32 v2, s27, v1
    s_lshl_b32 s28, s32, 14
    v_add_u32 v217, s28, v1
    s_lshl_b32 s26, s26, 1
    s_lshl_b32 s27, s21, 3
    s_add_u32 s26, s26, s27
    s_add_u32 s30, s26, s32
    s_xor_b32 s26, s30, 1
    s_add_u32 s29, s27, s22
    s_lshl_b32 s28, s20, 17
    s_lshl_b32 s41, s30, 11
    s_add_u32 s41, s41, s28
    s_lshl_b32 s42, s26, 11
    s_add_u32 s42, s42, s28
    s_lshl_b32 s43, s29, 11
    s_add_u32 s43, s43, s28
    s_add_u32 s43, s43, 12582912
    s_lshl_b32 s26, s20, 18
    s_add_u32 s26, s26, 4194304
    s_mov_b32 s23, 0
    s_mov_b32 s14, 262144
    s_mov_b32 s15, 0x00020000
    s_mov_b32 s18, 33554432
    s_mov_b32 s19, 0x00020000
    s_mov_b32 m0, s40
    s_waitcnt lgkmcnt(0)
    s_add_u32 s12, s8, s26
    s_addc_u32 s13, s9, 0
    s_and_b32 s13, s13, 0xffff
    s_mov_b32 s16, s8
    s_and_b32 s17, s9, 0xffff
    s_cmp_lg_u32 s22, 1
    s_cbranch_scc1 L_at_rdy1
    s_mov_b32 s26, 0
    s_branch L_at_chk1
L_at_poll1:
    v_mov_b32 v216, s82
    s_mov_b64 exec, 0xff
    v_mov_b32 v216, 0
    buffer_atomic_add v216, v233, s[16:19], s53 offen sc0 sc1
    s_mov_b64 exec, -1
L_at_chk1:
    s_waitcnt vmcnt(0)
    v_cmp_ne_u32 s[34:35], s82, v216
    s_add_u32 s26, s26, 1
    s_nop 2
    s_cmp_eq_u64 s[34:35], 0
    s_cbranch_scc1 L_at_rdy1
    s_cmp_lt_u32 s26, 0x200000
    s_cbranch_scc1 L_at_poll1
L_at_rdy1:
    s_waitcnt lgkmcnt(0)
    s_barrier
    v_and_b32 v3, 31, v0
    v_lshlrev_b32 v3, 2, v3
    s_lshr_b32 s26, s41, 4
    s_add_u32 s26, s26, 27000832
    buffer_load_dword v24, v3, s[16:19], s26 offen sc1
    s_lshr_b32 s26, s42, 4
    s_add_u32 s26, s26, 27000832
    buffer_load_dword v40, v3, s[16:19], s26 offen sc1
    s_lshr_b32 s26, s40, 1
    s_add_u32 m0, s26, 98304
    v_add_u32 v8, s26, v1
    buffer_load_dwordx4 v1, s[16:19], s41 offen offset:0 sc1 lds
    buffer_load_dwordx4 v1, s[16:19], s41 offen offset:1024 sc1 lds
    s_mov_b32 m0, s40
    v_xor_b32 v16, 8192, v8
    v_add_u32 v8, 98304, v8
    v_add_u32 v16, 98304, v16
    s_bitcmp1_b32 s22, 1
    s_cbranch_scc1 L_at_late0
    buffer_load_dwordx4 v2, s[12:15], s23 offen offset:0 sc1 lds
    buffer_load_dwordx4 v2, s[12:15], s23 offen offset:1024 sc1 lds
    buffer_load_dwordx4 v2, s[12:15], s23 offen offset:2048 sc1 lds
    buffer_load_dwordx4 v2, s[12:15], s23 offen offset:3072 sc1 lds
L_at_late0:
    v_mov_b32 v229, 135232
    v_mov_b32 v7, 0
    ds_write_b32 v229, v7
    s_lshl_b32 s27, s20, 11
    s_add_u32 s27, s27, 16777216
    s_lshl_b32 s29, s29, 16
    s_add_u32 s29, s29, s27
    s_lshl_b32 s30, s30, 16
    s_add_u32 s30, s30, s27
    s_add_u32 s30, s30, 4194304
    s_mov_b32 s31, 0
    s_mov_b32 s46, 262144
    s_mov_b32 s45, 0
    s_lshl_b32 s44, 36, s32
    s_or_b32 s44, s44, 144
    s_cmp_eq_u32 s22, 0
    s_cselect_b32 s27, 3, 0
    s_or_b32 s44, s44, s27
    s_lshl_b32 s24, s21, 12
    s_lshl_b32 s27, s20, 7
    s_add_u32 s24, s24, s27
    s_add_u32 s24, s24, 26738688
    s_getpc_b64 s[48:49]
L_at_pc:
    s_lshr_b32 s27, s2, 3
    s_lshl_b32 s27, s27, 3
    s_add_u32 s27, s27, s22
    s_lshl_b32 s27, s27, 6
    s_min_u32 s27, s27, L_at_end-L_at_tail
    s_add_u32 s27, s27, L_at_tail-L_at_pc
    s_add_u32 s48, s48, s27
    s_addc_u32 s49, s49, 0
    v_lshrrev_b32 v230, 4, v0
    v_lshrrev_b32 v3, 2, v0
    v_xor_b32 v230, v230, v3
    v_and_b32 v230, 1, v230
    v_and_b32 v3, 3, v0
    v_or_b32 v230, v230, v3
    v_min_u32 v230, 1, v230
    v_sub_u32 v230, v230, 1
    v_and_b32 v136, 0x3f803f80, v230
    v_and_b32 v137, 0x3f803f80, v230
    v_and_b32 v138, 0x3f803f80, v230
    v_and_b32 v139, 0x3f803f80, v230
    v_lshlrev_b32 v218, 3, v0
    v_and_b32 v219, 0x78, v218
    v_add_u32 v218, 98304, v218
    v_add_u32 v219, 131072, v219
    s_cmp_lt_u32 s2, 128
    s_cselect_b32 s4, s4, s6
    s_cselect_b32 s5, s5, s7
    s_mov_b32 s36, s4
    s_and_b32 s37, s5, 0xffff
    s_mov_b32 s38, 2097152
    s_mov_b32 s39, 0x00020000
    s_lshr_b32 s47, s2, 3
    s_and_b32 s47, s47, 15
    s_lshl_b32 s47, s47, 3
    s_add_u32 s47, s47, s22
    s_lshl_b32 s47, s47, 14
    s_and_b32 s27, s2, 1
    s_lshl_b32 s27, s27, 10
    s_add_u32 s47, s47, s27
    s_lshr_b32 s51, s2, 5
    s_and_b32 s51, s51, 3
    s_lshl_b32 s51, s51, 8
    s_add_u32 s51, s51, s27
    v_and_b32 v220, 7, v0
    v_lshlrev_b32 v220, 7, v220
    v_lshrrev_b32 v221, 8, v0
    v_lshlrev_b32 v221, 10, v221
    v_and_b32 v6, 126, v0
    v_lshlrev_b32 v6, 3, v6
    v_add_u32 v221, v221, v6
    v_and_b32 v6, 128, v0
    v_lshrrev_b32 v6, 4, v6
    v_add_u32 v221, v221, v6
    v_and_b32 v6, 1, v0
    v_lshlrev_b32 v6, 2, v6
    v_add_u32 v221, v221, v6
    v_add_u32 v221, 133120, v221
    v_and_b32 v222, 4, v0
    v_lshlrev_b32 v222, 3, v222
    v_and_b32 v6, 8, v0
    v_lshlrev_b32 v6, 1, v6
    v_add_u32 v222, v222, v6
    v_and_b32 v6, 3, v0
    v_lshlrev_b32 v6, 2, v6
    v_add_u32 v222, v222, v6
    v_add_u32 v222, 135168, v222
    s_mul_i32 s26, s22, 4352
    s_add_u32 s26, s26, 98304
    v_add_u32 v223, s26, v1
    v_lshrrev_b32 v6, 2, v1
    v_add_u32 v224, s26, v6
    s_xor_b32 s27, s22, 4
    s_mul_i32 s26, s27, 4352
    s_add_u32 s26, s26, 98304
    v_add_u32 v225, s26, v1
    v_add_u32 v226, s26, v6
    v_add_u32 v227, 133120, v1
    v_lshrrev_b32 v228, 9, v1
    v_lshlrev_b32 v228, 4, v228
    v_add_u32 v228, 135168, v228
    v_lshrrev_b32 v6, 8, v1
    v_lshlrev_b32 v231, 11, v6
    v_lshlrev_b32 v6, 5, v6
    v_and_b32 v3, 0xf0, v1
    v_xor_b32 v6, v6, v3
    v_add_u32 v231, v231, v6
    s_and_b32 s26, s22, 3
    s_lshl_b32 s26, s26, 14
    v_add_u32 v231, s26, v231
    v_xor_b32 v232, 128, v231
    v_add_u32 v232, 7168, v232
    v_mov_b32 v88, 0
    v_mov_b32 v89, 0
    v_mov_b32 v90, 0
    v_mov_b32 v91, 0
    v_mov_b32 v92, 0
    v_mov_b32 v93, 0
    v_mov_b32 v94, 0
    v_mov_b32 v95, 0
    v_mov_b32 v96, 0
    v_mov_b32 v97, 0
    v_mov_b32 v98, 0
    v_mov_b32 v99, 0
    v_mov_b32 v100, 0
    v_mov_b32 v101, 0
    v_mov_b32 v102, 0
    v_mov_b32 v103, 0
    v_mov_b32 v120, 0
    v_mov_b32 v121, 0
    v_mov_b32 v122, 0
    v_mov_b32 v123, 0
    v_mov_b32 v104, 0
    v_mov_b32 v105, 0
    v_mov_b32 v106, 0
    v_mov_b32 v107, 0
    v_mov_b32 v108, 0
    v_mov_b32 v109, 0
    v_mov_b32 v110, 0
    v_mov_b32 v111, 0
    v_mov_b32 v112, 0
    v_mov_b32 v113, 0
    v_mov_b32 v114, 0
    v_mov_b32 v115, 0
    v_mov_b32 v116, 0
    v_mov_b32 v117, 0
    v_mov_b32 v118, 0
    v_mov_b32 v119, 0
    v_mov_b32 v124, 0
    v_mov_b32 v125, 0
    v_mov_b32 v126, 0
    v_mov_b32 v127, 0
    v_mov_b32 v132, 0
    v_mov_b32 v133, 0
    v_mov_b32 v134, 0
    v_mov_b32 v135, 0
    v_mov_b32 v4, v217
    v_add_u32 v5, 32768, v217
    s_mov_b32 s33, 32768
    s_mov_b32 s25, 0
    s_bitcmp1_b32 s22, 1
    s_cbranch_scc0 L_at_early0
    s_waitcnt vmcnt(0)
    buffer_load_dwordx4 v2, s[12:15], s23 offen offset:0 sc1 lds
    buffer_load_dwordx4 v2, s[12:15], s23 offen offset:1024 sc1 lds
    buffer_load_dwordx4 v2, s[12:15], s23 offen offset:2048 sc1 lds
    buffer_load_dwordx4 v2, s[12:15], s23 offen offset:3072 sc1 lds
L_at_early0:
    s_waitcnt vmcnt(4)
    s_mov_b32 s23, 16384
    v_mov_b32 v25, v24
    v_mov_b32 v26, v24
    v_mov_b32 v27, v24
    v_mov_b32 v28, v24
    v_mov_b32 v29, v24
    v_mov_b32 v30, v24
    v_mov_b32 v31, v24
    v_mov_b32 v32, v24
    v_mov_b32 v33, v24
    v_mov_b32 v34, v24
    v_mov_b32 v35, v24
    v_mov_b32 v36, v24
    v_mov_b32 v37, v24
    v_mov_b32 v38, v24
    v_mov_b32 v39, v24
    v_mov_b32 v41, v40
    v_mov_b32 v42, v40
    v_mov_b32 v43, v40
    v_mov_b32 v44, v40
    v_mov_b32 v45, v40
    v_mov_b32 v46, v40
    v_mov_b32 v47, v40
    v_mov_b32 v48, v40
    v_mov_b32 v49, v40
    v_mov_b32 v50, v40
    v_mov_b32 v51, v40
    v_mov_b32 v52, v40
    v_mov_b32 v53, v40
    v_mov_b32 v54, v40
    v_mov_b32 v55, v40
    s_bitcmp1_b32 s22, 1
    s_cbranch_scc1 L_at_nowait0
    s_waitcnt vmcnt(0)
L_at_nowait0:
    s_waitcnt lgkmcnt(0)
    s_barrier
    ds_read_b128 v[12:15], v8 offset:1024
    ds_read_b128 v[8:11], v8
    ds_read_b128 v[20:23], v16 offset:1024
    ds_read_b128 v[16:19], v16
    ds_read_b128 v[140:143], v217
    ds_read_b128 v[144:147], v217 offset:1024
    ds_read_b128 v[148:151], v217 offset:4096
    ds_read_b128 v[152:155], v217 offset:5120
    ds_read_b128 v[156:159], v217 offset:2048
    ds_read_b128 v[160:163], v217 offset:3072
L_at_go:
    v_mov_b32 v168, 0
    v_mov_b32 v169, 0
    v_mov_b32 v170, 0
    v_mov_b32 v171, 0
    v_mov_b32 v86, 0
    v_mov_b32 v87, 0
    s_waitcnt lgkmcnt(4)
    v_mfma_f32_32x32x16_bf16 v[56:71], v[140:143], v[8:11], v[24:39]
    v_mfma_f32_32x32x16_bf16 v[56:71], v[144:147], v[12:15], v[56:71]
    s_waitcnt lgkmcnt(0)
    s_nop 7
    s_nop 2
.p2align 6
L_at_loop:
    v_exp_f32 v56, v56
    s_waitcnt lgkmcnt(2)
    v_cvt_pk_bf16_f32 v135, v86, v87
    v_mfma_f32_32x32x16_bf16 v[72:87], v[140:143], v[16:19], v[40:55]
    s_cmp_lt_u32 s25, 7
    v_exp_f32 v57, v57
    s_cselect_b32 s14, s46, 0
    v_exp_f32 v58, v58
    s_add_u32 m0, s40, s33
    v_exp_f32 v59, v59
    v_mfma_f32_32x32x16_bf16 v[104:119], v[168:171], v[132:135], v[104:119]
    ds_read_b128 v[164:167], v4 offset:6144
    v_exp_f32 v60, v60
    v_cvt_pk_bf16_f32 v128, v56, v57
    v_exp_f32 v61, v61
    ds_read_b128 v[168:171], v4 offset:7168
    v_cvt_pk_bf16_f32 v129, v58, v59
    v_mfma_f32_16x16x32_bf16 v[124:127], v[136:139], v[132:135], v[124:127]
    v_exp_f32 v62, v62
    v_exp_f32 v63, v63
    v_mfma_f32_32x32x16_bf16 v[72:87], v[144:147], v[20:23], v[72:87]
    buffer_load_dwordx4 v2, s[12:15], s23 offen offset:0 sc1 lds
    v_cvt_pk_bf16_f32 v130, v60, v61
    v_cvt_pk_bf16_f32 v131, v62, v63
    v_exp_f32 v64, v64
    v_exp_f32 v65, v65
    v_mfma_f32_32x32x16_bf16 v[88:103], v[156:159], v[128:131], v[88:103]
    buffer_load_dwordx4 v2, s[12:15], s23 offen offset:1024 sc1 lds
    v_exp_f32 v66, v66
    v_exp_f32 v67, v67
    v_cvt_pk_bf16_f32 v132, v64, v65
    v_exp_f32 v68, v68
    v_mfma_f32_16x16x32_bf16 v[120:123], v[136:139], v[128:131], v[120:123]
    v_cvt_pk_bf16_f32 v133, v66, v67
    v_exp_f32 v69, v69
    buffer_load_dwordx4 v2, s[12:15], s23 offen offset:2048 sc1 lds
    v_exp_f32 v70, v70
    buffer_load_dwordx4 v2, s[12:15], s23 offen offset:3072 sc1 lds
    v_exp_f32 v71, v71
    v_cvt_pk_bf16_f32 v134, v68, v69
    v_exp_f32 v72, v72
    s_waitcnt lgkmcnt(2)
    s_setprio 1
    v_cvt_pk_bf16_f32 v135, v70, v71
    v_mfma_f32_32x32x16_bf16 v[56:71], v[148:151], v[8:11], v[24:39]
    s_cmp_eq_u32 s25, s45
    v_exp_f32 v73, v73
    s_cbranch_scc1 L_at_first
L_at_first_ret:
    v_exp_f32 v74, v74
    s_add_u32 s23, s23, 16384
    v_exp_f32 v75, v75
    v_mfma_f32_32x32x16_bf16 v[88:103], v[160:163], v[132:135], v[88:103]
    ds_read_b128 v[140:143], v4 offset:8192
    v_exp_f32 v76, v76
    v_cvt_pk_bf16_f32 v128, v72, v73
    v_exp_f32 v77, v77
    ds_read_b128 v[144:147], v4 offset:9216
    v_cvt_pk_bf16_f32 v129, v74, v75
    v_mfma_f32_16x16x32_bf16 v[120:123], v[136:139], v[132:135], v[120:123]
    v_exp_f32 v78, v78
    v_exp_f32 v79, v79
    v_mfma_f32_32x32x16_bf16 v[56:71], v[152:155], v[12:15], v[56:71]
    v_cvt_pk_bf16_f32 v130, v76, v77
    v_cvt_pk_bf16_f32 v131, v78, v79
    v_exp_f32 v80, v80
    v_exp_f32 v81, v81
    v_mfma_f32_32x32x16_bf16 v[104:119], v[156:159], v[128:131], v[104:119]
    v_exp_f32 v82, v82
    v_exp_f32 v83, v83
    v_cvt_pk_bf16_f32 v132, v80, v81
    v_exp_f32 v84, v84
    v_mfma_f32_16x16x32_bf16 v[124:127], v[136:139], v[128:131], v[124:127]
    v_cvt_pk_bf16_f32 v133, v82, v83
    v_exp_f32 v85, v85
    v_exp_f32 v86, v86
    v_exp_f32 v87, v87
    v_cvt_pk_bf16_f32 v134, v84, v85
    v_exp_f32 v56, v56
    s_waitcnt lgkmcnt(2)
    v_cvt_pk_bf16_f32 v135, v86, v87
    v_mfma_f32_32x32x16_bf16 v[72:87], v[148:151], v[16:19], v[40:55]
    v_exp_f32 v57, v57
    v_exp_f32 v58, v58
    v_exp_f32 v59, v59
    v_mfma_f32_32x32x16_bf16 v[104:119], v[160:163], v[132:135], v[104:119]
    ds_read_b128 v[156:159], v4 offset:10240
    v_exp_f32 v60, v60
    v_cvt_pk_bf16_f32 v128, v56, v57
    v_exp_f32 v61, v61
    ds_read_b128 v[160:163], v4 offset:11264
    v_cvt_pk_bf16_f32 v129, v58, v59
    v_mfma_f32_16x16x32_bf16 v[124:127], v[136:139], v[132:135], v[124:127]
    v_exp_f32 v62, v62
    v_exp_f32 v63, v63
    v_mfma_f32_32x32x16_bf16 v[72:87], v[152:155], v[20:23], v[72:87]
    v_cvt_pk_bf16_f32 v130, v60, v61
    v_cvt_pk_bf16_f32 v131, v62, v63
    v_exp_f32 v64, v64
    v_exp_f32 v65, v65
    v_mfma_f32_32x32x16_bf16 v[88:103], v[164:167], v[128:131], v[88:103]
    v_exp_f32 v66, v66
    v_exp_f32 v67, v67
    v_cvt_pk_bf16_f32 v132, v64, v65
    v_exp_f32 v68, v68
    v_mfma_f32_16x16x32_bf16 v[120:123], v[136:139], v[128:131], v[120:123]
    v_cvt_pk_bf16_f32 v133, v66, v67
    v_exp_f32 v69, v69
    v_exp_f32 v70, v70
    v_exp_f32 v71, v71
    v_cvt_pk_bf16_f32 v134, v68, v69
    v_exp_f32 v72, v72
    s_waitcnt lgkmcnt(2)
    s_setprio 0
    v_cvt_pk_bf16_f32 v135, v70, v71
    v_mfma_f32_32x32x16_bf16 v[56:71], v[140:143], v[8:11], v[24:39]
    v_exp_f32 v73, v73
    v_exp_f32 v74, v74
    v_exp_f32 v75, v75
    v_mfma_f32_32x32x16_bf16 v[88:103], v[168:171], v[132:135], v[88:103]
    ds_read_b128 v[148:151], v4 offset:12288
    v_exp_f32 v76, v76
    v_cvt_pk_bf16_f32 v128, v72, v73
    v_exp_f32 v77, v77
    ds_read_b128 v[152:155], v4 offset:13312
    v_cvt_pk_bf16_f32 v129, v74, v75
    v_mfma_f32_16x16x32_bf16 v[120:123], v[136:139], v[132:135], v[120:123]
    v_exp_f32 v78, v78
    v_exp_f32 v79, v79
    v_mfma_f32_32x32x16_bf16 v[56:71], v[144:147], v[12:15], v[56:71]
    v_cvt_pk_bf16_f32 v130, v76, v77
    v_cvt_pk_bf16_f32 v131, v78, v79
    v_exp_f32 v80, v80
    v_exp_f32 v81, v81
    v_mfma_f32_32x32x16_bf16 v[104:119], v[164:167], v[128:131], v[104:119]
    v_exp_f32 v82, v82
    v_exp_f32 v83, v83
    v_cvt_pk_bf16_f32 v132, v80, v81
    v_exp_f32 v84, v84
    v_mfma_f32_16x16x32_bf16 v[124:127], v[136:139], v[128:131], v[124:127]
    v_cvt_pk_bf16_f32 v133, v82, v83
    v_exp_f32 v85, v85
    v_exp_f32 v86, v86
    v_exp_f32 v87, v87
    v_cvt_pk_bf16_f32 v134, v84, v85
    v_exp_f32 v56, v56
    s_waitcnt lgkmcnt(2)
    v_cvt_pk_bf16_f32 v135, v86, v87
    v_mfma_f32_32x32x16_bf16 v[72:87], v[140:143], v[16:19], v[40:55]
    v_exp_f32 v57, v57
    v_exp_f32 v58, v58
    v_exp_f32 v59, v59
    v_mfma_f32_32x32x16_bf16 v[104:119], v[168:171], v[132:135], v[104:119]
    ds_read_b128 v[164:167], v4 offset:14336
    v_exp_f32 v60, v60
    v_cvt_pk_bf16_f32 v128, v56, v57
    v_exp_f32 v61, v61
    ds_read_b128 v[168:171], v4 offset:15360
    v_cvt_pk_bf16_f32 v129, v58, v59
    v_mfma_f32_16x16x32_bf16 v[124:127], v[136:139], v[132:135], v[124:127]
    v_exp_f32 v62, v62
    v_exp_f32 v63, v63
    v_mfma_f32_32x32x16_bf16 v[72:87], v[144:147], v[20:23], v[72:87]
    v_cvt_pk_bf16_f32 v130, v60, v61
    v_cvt_pk_bf16_f32 v131, v62, v63
    v_exp_f32 v64, v64
    v_exp_f32 v65, v65
    v_mfma_f32_32x32x16_bf16 v[88:103], v[156:159], v[128:131], v[88:103]
    v_exp_f32 v66, v66
    v_exp_f32 v67, v67
    v_cvt_pk_bf16_f32 v132, v64, v65
    v_exp_f32 v68, v68
    v_mfma_f32_16x16x32_bf16 v[120:123], v[136:139], v[128:131], v[120:123]
    v_cvt_pk_bf16_f32 v133, v66, v67
    v_exp_f32 v69, v69
    v_exp_f32 v70, v70
    v_exp_f32 v71, v71
    v_cvt_pk_bf16_f32 v134, v68, v69
    v_exp_f32 v72, v72
    s_waitcnt vmcnt(0) lgkmcnt(2)
    s_barrier
    s_setprio 3
    v_cvt_pk_bf16_f32 v135, v70, v71
    v_mfma_f32_32x32x16_bf16 v[56:71], v[148:151], v[8:11], v[24:39]
    v_exp_f32 v73, v73
    v_exp_f32 v74, v74
    v_exp_f32 v75, v75
    v_mfma_f32_32x32x16_bf16 v[88:103], v[160:163], v[132:135], v[88:103]
    ds_read_b128 v[140:143], v5 offset:0
    v_exp_f32 v76, v76
    v_cvt_pk_bf16_f32 v128, v72, v73
    v_exp_f32 v77, v77
    ds_read_b128 v[144:147], v5 offset:1024
    v_cvt_pk_bf16_f32 v129, v74, v75
    v_mfma_f32_16x16x32_bf16 v[120:123], v[136:139], v[132:135], v[120:123]
    v_exp_f32 v78, v78
    v_exp_f32 v79, v79
    v_mfma_f32_32x32x16_bf16 v[56:71], v[152:155], v[12:15], v[56:71]
    v_cvt_pk_bf16_f32 v130, v76, v77
    v_cvt_pk_bf16_f32 v131, v78, v79
    v_exp_f32 v80, v80
    v_exp_f32 v81, v81
    v_mfma_f32_32x32x16_bf16 v[104:119], v[156:159], v[128:131], v[104:119]
    v_exp_f32 v82, v82
    v_exp_f32 v83, v83
    v_cvt_pk_bf16_f32 v132, v80, v81
    v_exp_f32 v84, v84
    v_mfma_f32_16x16x32_bf16 v[124:127], v[136:139], v[128:131], v[124:127]
    v_cvt_pk_bf16_f32 v133, v82, v83
    v_exp_f32 v85, v85
    v_exp_f32 v86, v86
    v_exp_f32 v87, v87
    v_cvt_pk_bf16_f32 v134, v84, v85
    v_exp_f32 v56, v56
    s_waitcnt lgkmcnt(2)
    v_cvt_pk_bf16_f32 v135, v86, v87
    v_mfma_f32_32x32x16_bf16 v[72:87], v[148:151], v[16:19], v[40:55]
    s_bitcmp1_b32 s44, s25
    v_exp_f32 v57, v57
    s_cbranch_scc1 L_at_hook
L_at_hook_ret:
    v_exp_f32 v58, v58
    s_add_u32 s25, s25, 1
    v_exp_f32 v59, v59
    v_mfma_f32_32x32x16_bf16 v[104:119], v[160:163], v[132:135], v[104:119]
    ds_read_b128 v[156:159], v5 offset:2048
    v_exp_f32 v60, v60
    v_cvt_pk_bf16_f32 v128, v56, v57
    v_exp_f32 v61, v61
    ds_read_b128 v[160:163], v5 offset:3072
    v_cvt_pk_bf16_f32 v129, v58, v59
    v_mfma_f32_16x16x32_bf16 v[124:127], v[136:139], v[132:135], v[124:127]
    v_exp_f32 v62, v62
    v_exp_f32 v63, v63
    v_mfma_f32_32x32x16_bf16 v[72:87], v[152:155], v[20:23], v[72:87]
    buffer_load_dword v216, v220, s[36:39], s47 offen
    v_cvt_pk_bf16_f32 v130, v60, v61
    v_cvt_pk_bf16_f32 v131, v62, v63
    v_exp_f32 v64, v64
    v_exp_f32 v65, v65
    v_mfma_f32_32x32x16_bf16 v[88:103], v[164:167], v[128:131], v[88:103]
    s_add_u32 s47, s47, 2048
    v_exp_f32 v66, v66
    v_exp_f32 v67, v67
    v_cvt_pk_bf16_f32 v132, v64, v65
    v_exp_f32 v68, v68
    v_mfma_f32_16x16x32_bf16 v[120:123], v[136:139], v[128:131], v[120:123]
    v_cvt_pk_bf16_f32 v133, v66, v67
    v_exp_f32 v69, v69
    v_exp_f32 v70, v70
    v_exp_f32 v71, v71
    v_cvt_pk_bf16_f32 v134, v68, v69
    v_exp_f32 v72, v72
    s_waitcnt lgkmcnt(2)
    s_setprio 2
    v_cvt_pk_bf16_f32 v135, v70, v71
    v_mfma_f32_32x32x16_bf16 v[56:71], v[140:143], v[8:11], v[24:39]
    s_add_u32 s33, s33, 32768
    v_exp_f32 v73, v73
    s_cmp_eq_u32 s33, 98304
    v_exp_f32 v74, v74
    s_cselect_b32 s33, 0, s33
    v_exp_f32 v75, v75
    v_mfma_f32_32x32x16_bf16 v[88:103], v[168:171], v[132:135], v[88:103]
    ds_read_b128 v[148:151], v5 offset:4096
    v_exp_f32 v76, v76
    v_cvt_pk_bf16_f32 v128, v72, v73
    v_exp_f32 v77, v77
    ds_read_b128 v[152:155], v5 offset:5120
    v_cvt_pk_bf16_f32 v129, v74, v75
    v_mfma_f32_16x16x32_bf16 v[120:123], v[136:139], v[132:135], v[120:123]
    v_exp_f32 v78, v78
    v_exp_f32 v79, v79
    v_mfma_f32_32x32x16_bf16 v[56:71], v[144:147], v[12:15], v[56:71]
    s_cmp_lt_u32 s25, 8
    v_cvt_pk_bf16_f32 v130, v76, v77
    v_cvt_pk_bf16_f32 v131, v78, v79
    v_exp_f32 v80, v80
    v_exp_f32 v81, v81
    v_mfma_f32_32x32x16_bf16 v[104:119], v[164:167], v[128:131], v[104:119]
    v_exp_f32 v82, v82
    v_exp_f32 v83, v83
    v_cvt_pk_bf16_f32 v132, v80, v81
    v_exp_f32 v84, v84
    v_mfma_f32_16x16x32_bf16 v[124:127], v[136:139], v[128:131], v[124:127]
    v_cvt_pk_bf16_f32 v133, v82, v83
    v_exp_f32 v85, v85
    v_exp_f32 v86, v86
    v_exp_f32 v87, v87
    v_cvt_pk_bf16_f32 v134, v84, v85
    v_mov_b32 v4, v5
    v_add_u32 v5, s33, v217
    s_cbranch_scc1 L_at_loop
L_at_tail:
    v_cvt_pk_bf16_f32 v135, v86, v87
    v_mov_b32 v3, 0x5d800000
    v_mov_b32 v7, 1
    v_mfma_f32_16x16x32_bf16 v[124:127], v[136:139], v[132:135], v[124:127]
    v_mfma_f32_32x32x16_bf16 v[104:119], v[168:171], v[132:135], v[104:119]
    v_cmp_nlt_f32 vcc, v120, v3
    s_nop 5
    v_cmp_nlt_f32 s[34:35], v124, v3
    ds_write_b32 v224, v124 offset:4096
    s_nop 0
    s_or_b64 vcc, vcc, s[34:35]
    s_and_saveexec_b64 s[34:35], vcc
    ds_write_b32 v229, v7
    s_mov_b64 exec, s[34:35]
    ds_write_b128 v223, v[104:107] offset:0
    ds_write_b128 v223, v[108:111] offset:1024
    ds_write_b128 v223, v[112:115] offset:2048
    ds_write_b128 v223, v[116:119] offset:3072
    s_waitcnt lgkmcnt(0)
    s_barrier
    ds_read_b32 v6, v229
    ds_read_b32 v124, v226 offset:4096
    ds_read_b128 v[104:107], v225 offset:0
    ds_read_b128 v[108:111], v225 offset:1024
    ds_read_b128 v[112:115], v225 offset:2048
    ds_read_b128 v[116:119], v225 offset:3072
    s_waitcnt lgkmcnt(4)
    v_readfirstlane_b32 s26, v6
    v_add_f32 v120, v120, v124
    v_rcp_f32 v120, v120
    s_xor_b32 s27, s31, 1
    s_and_b32 s26, s26, s27
    s_cmp_lg_u32 s26, 0
    s_cbranch_scc1 L_at_fallback
    v_mov_b32 v121, v120
    s_waitcnt lgkmcnt(2)
    v_pk_add_f32 v[88:89], v[88:89], v[104:105]
    v_pk_add_f32 v[90:91], v[90:91], v[106:107]
    v_pk_add_f32 v[92:93], v[92:93], v[108:109]
    v_pk_add_f32 v[94:95], v[94:95], v[110:111]
    v_pk_mul_f32 v[88:89], v[88:89], v[120:121]
    v_pk_mul_f32 v[90:91], v[90:91], v[120:121]
    v_pk_mul_f32 v[92:93], v[92:93], v[120:121]
    v_pk_mul_f32 v[94:95], v[94:95], v[120:121]
    v_cvt_pk_bf16_f32 v128, v88, v89
    v_cvt_pk_bf16_f32 v129, v90, v91
    v_cvt_pk_bf16_f32 v130, v92, v93
    v_cvt_pk_bf16_f32 v131, v94, v95
    buffer_store_dwordx4 v[128:131], v1, s[16:19], s30 offen offset:0 sc1
    s_waitcnt lgkmcnt(0)
    v_pk_add_f32 v[96:97], v[96:97], v[112:113]
    v_pk_add_f32 v[98:99], v[98:99], v[114:115]
    v_pk_add_f32 v[100:101], v[100:101], v[116:117]
    v_pk_add_f32 v[102:103], v[102:103], v[118:119]
    v_pk_mul_f32 v[96:97], v[96:97], v[120:121]
    v_pk_mul_f32 v[98:99], v[98:99], v[120:121]
    v_pk_mul_f32 v[100:101], v[100:101], v[120:121]
    v_pk_mul_f32 v[102:103], v[102:103], v[120:121]
    v_cvt_pk_bf16_f32 v132, v96, v97
    v_cvt_pk_bf16_f32 v133, v98, v99
    v_cvt_pk_bf16_f32 v134, v100, v101
    v_cvt_pk_bf16_f32 v135, v102, v103
    buffer_store_dwordx4 v[132:135], v1, s[16:19], s30 offen offset:1024 sc1
    s_setprio 0
    s_and_b32 s26, s2, 7
    s_lshr_b32 s27, s2, 3
    s_lshr_b32 s41, s2, 7
    s_lshr_b32 s42, s26, 1
    s_lshl_b32 s42, s42, 2
    s_and_b32 s28, s27, 3
    s_add_u32 s42, s42, s28
    s_lshr_b32 s43, s51, 8
    v_lshrrev_b32 v180, 4, v1
    v_lshrrev_b32 v181, 4, v180
    s_mov_b32 s25, 0
    s_cmp_lt_u32 s22, 4
    s_cbranch_scc1 L_op_cons
    s_and_b32 s26, s22, 3
    s_lshl_b32 s46, s26, 11
    s_lshl_b32 s44, s43, 8
    s_add_u32 s44, s44, 262144
    s_lshl_b32 s45, s42, 2
    s_add_u32 s45, s45, s26
    s_lshl_b32 s45, s45, 16
    s_lshl_b32 s28, s41, 22
    s_add_u32 s45, s45, s28
    s_add_u32 s45, s45, 16777216
    s_waitcnt vmcnt(0)
    s_barrier
    s_mov_b32 s12, s10
    s_and_b32 s13, s11, 0xffff
    s_mov_b32 s14, 8388608
    s_mov_b32 s15, 0x00020000
    v_lshrrev_b32 v181, 4, v180
    v_lshlrev_b32 v182, 4, v181
    v_xor_b32 v185, v182, v1
    s_lshl_b32 s27, s22, 12
    s_add_u32 s27, s27, 98304
    v_add_u32 v185, s27, v185
    v_lshlrev_b32 v186, 12, v181
    v_and_b32 v182, 0xf0, v1
    v_add_u32 v186, v186, v182
    s_lshl_b32 s47, s42, 3
    s_add_u32 s47, s47, s22
    s_lshl_b32 s47, s47, 16
    s_lshl_b32 s27, s41, 11
    s_add_u32 s47, s47, s27
    s_lshl_b32 s27, s43, 8
    s_add_u32 s47, s47, s27
    s_add_u32 m0, s46, 32768
    s_nop 0
    buffer_load_dwordx4 v231, s[36:39], s44 offen lds
    buffer_load_dwordx4 v232, s[36:39], s44 offen offset:1024 lds
    s_add_u32 s44, s44, 65536
    s_add_u32 m0, s46, 40960
    s_nop 0
    buffer_load_dwordx4 v231, s[36:39], s44 offen lds
    buffer_load_dwordx4 v232, s[36:39], s44 offen offset:1024 lds
    s_add_u32 s44, s44, 65536
    s_add_u32 m0, s46, 49152
    s_nop 0
    buffer_load_dwordx4 v231, s[36:39], s44 offen lds
    buffer_load_dwordx4 v232, s[36:39], s44 offen offset:1024 lds
    s_add_u32 s44, s44, 65536
    s_add_u32 m0, s46, 57344
    s_nop 0
    buffer_load_dwordx4 v231, s[36:39], s44 offen lds
    buffer_load_dwordx4 v232, s[36:39], s44 offen offset:1024 lds
    s_add_u32 s44, s44, 65536
    s_barrier
    s_add_u32 m0, s46, 0
    s_nop 0
    buffer_load_dwordx4 v1, s[16:19], s45 offen sc1 lds
    buffer_load_dwordx4 v1, s[16:19], s45 offen offset:1024 sc1 lds
    s_add_u32 s45, s45, 2048
    s_add_u32 m0, s46, 8192
    s_nop 0
    buffer_load_dwordx4 v1, s[16:19], s45 offen sc1 lds
    buffer_load_dwordx4 v1, s[16:19], s45 offen offset:1024 sc1 lds
    s_add_u32 s45, s45, 2048
    s_add_u32 m0, s46, 16384
    s_nop 0
    buffer_load_dwordx4 v1, s[16:19], s45 offen sc1 lds
    buffer_load_dwordx4 v1, s[16:19], s45 offen offset:1024 sc1 lds
    s_add_u32 s45, s45, 2048
    s_add_u32 m0, s46, 24576
    s_nop 0
    buffer_load_dwordx4 v1, s[16:19], s45 offen sc1 lds
    buffer_load_dwordx4 v1, s[16:19], s45 offen offset:1024 sc1 lds
    s_add_u32 s45, s45, 2048
    s_waitcnt vmcnt(6)
    s_barrier
    s_waitcnt vmcnt(4)
    s_barrier
    s_add_u32 m0, s46, 0
    s_nop 0
    buffer_load_dwordx4 v1, s[16:19], s45 offen sc1 lds
    buffer_load_dwordx4 v1, s[16:19], s45 offen offset:1024 sc1 lds
    s_add_u32 s45, s45, 2048
    s_add_u32 m0, s46, 65536
    s_nop 0
    buffer_load_dwordx4 v231, s[36:39], s44 offen lds
    buffer_load_dwordx4 v232, s[36:39], s44 offen offset:1024 lds
    s_add_u32 s44, s44, 65536
    s_waitcnt vmcnt(6)
    s_barrier
    s_add_u32 m0, s46, 8192
    s_nop 0
    buffer_load_dwordx4 v1, s[16:19], s45 offen sc1 lds
    buffer_load_dwordx4 v1, s[16:19], s45 offen offset:1024 sc1 lds
    s_add_u32 s45, s45, 2048
    s_add_u32 m0, s46, 73728
    s_nop 0
    buffer_load_dwordx4 v231, s[36:39], s44 offen lds
    buffer_load_dwordx4 v232, s[36:39], s44 offen offset:1024 lds
    s_add_u32 s44, s44, 65536
    s_waitcnt vmcnt(8)
    s_barrier
    s_add_u32 m0, s46, 16384
    s_nop 0
    buffer_load_dwordx4 v1, s[16:19], s45 offen sc1 lds
    buffer_load_dwordx4 v1, s[16:19], s45 offen offset:1024 sc1 lds
    s_add_u32 s45, s45, 2048
    s_add_u32 m0, s46, 81920
    s_nop 0
    buffer_load_dwordx4 v231, s[36:39], s44 offen lds
    buffer_load_dwordx4 v232, s[36:39], s44 offen offset:1024 lds
    s_add_u32 s44, s44, 65536
    s_waitcnt vmcnt(10)
    s_barrier
    s_add_u32 m0, s46, 24576
    s_nop 0
    buffer_load_dwordx4 v1, s[16:19], s45 offen sc1 lds
    buffer_load_dwordx4 v1, s[16:19], s45 offen offset:1024 sc1 lds
    s_add_u32 s45, s45, 2048
    s_add_u32 m0, s46, 90112
    s_nop 0
    buffer_load_dwordx4 v231, s[36:39], s44 offen lds
    buffer_load_dwordx4 v232, s[36:39], s44 offen offset:1024 lds
    s_add_u32 s44, s44, 65536
    s_waitcnt vmcnt(10)
    s_barrier
L_op_lloop:
    s_add_u32 m0, s46, 0
    s_nop 0
    buffer_load_dwordx4 v1, s[16:19], s45 offen sc1 lds
    buffer_load_dwordx4 v1, s[16:19], s45 offen offset:1024 sc1 lds
    s_add_u32 s45, s45, 2048
    s_add_u32 m0, s46, 32768
    s_nop 0
    buffer_load_dwordx4 v231, s[36:39], s44 offen lds
    buffer_load_dwordx4 v232, s[36:39], s44 offen offset:1024 lds
    s_add_u32 s44, s44, 65536
    s_waitcnt vmcnt(10)
    s_barrier
    s_add_u32 m0, s46, 8192
    s_nop 0
    buffer_load_dwordx4 v1, s[16:19], s45 offen sc1 lds
    buffer_load_dwordx4 v1, s[16:19], s45 offen offset:1024 sc1 lds
    s_add_u32 s45, s45, 2048
    s_add_u32 m0, s46, 40960
    s_nop 0
    buffer_load_dwordx4 v231, s[36:39], s44 offen lds
    buffer_load_dwordx4 v232, s[36:39], s44 offen offset:1024 lds
    s_add_u32 s44, s44, 65536
    s_waitcnt vmcnt(10)
    s_barrier
    s_add_u32 m0, s46, 16384
    s_nop 0
    buffer_load_dwordx4 v1, s[16:19], s45 offen sc1 lds
    buffer_load_dwordx4 v1, s[16:19], s45 offen offset:1024 sc1 lds
    s_add_u32 s45, s45, 2048
    s_add_u32 m0, s46, 49152
    s_nop 0
    buffer_load_dwordx4 v231, s[36:39], s44 offen lds
    buffer_load_dwordx4 v232, s[36:39], s44 offen offset:1024 lds
    s_add_u32 s44, s44, 65536
    s_waitcnt vmcnt(10)
    s_barrier
    s_add_u32 m0, s46, 24576
    s_nop 0
    buffer_load_dwordx4 v1, s[16:19], s45 offen sc1 lds
    buffer_load_dwordx4 v1, s[16:19], s45 offen offset:1024 sc1 lds
    s_add_u32 s45, s45, 2048
    s_add_u32 m0, s46, 57344
    s_nop 0
    buffer_load_dwordx4 v231, s[36:39], s44 offen lds
    buffer_load_dwordx4 v232, s[36:39], s44 offen offset:1024 lds
    s_add_u32 s44, s44, 65536
    s_waitcnt vmcnt(10)
    s_barrier
    s_add_u32 m0, s46, 0
    s_nop 0
    buffer_load_dwordx4 v1, s[16:19], s45 offen sc1 lds
    buffer_load_dwordx4 v1, s[16:19], s45 offen offset:1024 sc1 lds
    s_add_u32 s45, s45, 2048
    s_add_u32 m0, s46, 65536
    s_nop 0
    buffer_load_dwordx4 v231, s[36:39], s44 offen lds
    buffer_load_dwordx4 v232, s[36:39], s44 offen offset:1024 lds
    s_add_u32 s44, s44, 65536
    s_waitcnt vmcnt(10)
    s_barrier
    s_add_u32 m0, s46, 8192
    s_nop 0
    buffer_load_dwordx4 v1, s[16:19], s45 offen sc1 lds
    buffer_load_dwordx4 v1, s[16:19], s45 offen offset:1024 sc1 lds
    s_add_u32 s45, s45, 2048
    s_add_u32 m0, s46, 73728
    s_nop 0
    buffer_load_dwordx4 v231, s[36:39], s44 offen lds
    buffer_load_dwordx4 v232, s[36:39], s44 offen offset:1024 lds
    s_add_u32 s44, s44, 65536
    s_waitcnt vmcnt(10)
    s_barrier
    s_add_u32 m0, s46, 16384
    s_nop 0
    buffer_load_dwordx4 v1, s[16:19], s45 offen sc1 lds
    buffer_load_dwordx4 v1, s[16:19], s45 offen offset:1024 sc1 lds
    s_add_u32 s45, s45, 2048
    s_add_u32 m0, s46, 81920
    s_nop 0
    buffer_load_dwordx4 v231, s[36:39], s44 offen lds
    buffer_load_dwordx4 v232, s[36:39], s44 offen offset:1024 lds
    s_add_u32 s44, s44, 65536
    s_waitcnt vmcnt(10)
    s_barrier
    s_add_u32 m0, s46, 24576
    s_nop 0
    buffer_load_dwordx4 v1, s[16:19], s45 offen sc1 lds
    buffer_load_dwordx4 v1, s[16:19], s45 offen offset:1024 sc1 lds
    s_add_u32 s45, s45, 2048
    s_add_u32 m0, s46, 90112
    s_nop 0
    buffer_load_dwordx4 v231, s[36:39], s44 offen lds
    buffer_load_dwordx4 v232, s[36:39], s44 offen offset:1024 lds
    s_add_u32 s44, s44, 65536
    s_waitcnt vmcnt(10)
    s_barrier
    s_add_u32 s25, s25, 1
    s_cmp_lt_u32 s25, 3
    s_cbranch_scc1 L_op_lloop
    s_waitcnt vmcnt(6)
    s_barrier
    s_waitcnt vmcnt(0)
    s_barrier
    s_branch L_op_store
L_op_cons:
    s_lshr_b32 s48, s42, 1
    s_lshl_b32 s28, s41, 3
    s_add_u32 s48, s48, s28
    s_lshl_b32 s48, s48, 12
    s_add_u32 s48, s48, 26738688
    s_add_u32 s24, s24, 32768
    v_and_b32 v187, 31, v180
    v_lshlrev_b32 v187, 7, v187
    v_and_b32 v182, 15, v180
    s_and_b32 s27, s22, 1
    s_lshr_b32 s28, s22, 1
    v_lshlrev_b32 v172, 9, v181
    v_lshlrev_b32 v183, 4, v182
    v_add_u32 v172, v172, v183
    s_lshl_b32 s26, s27, 12
    s_add_u32 s26, s26, 0
    v_add_u32 v172, s26, v172
    v_lshrrev_b32 v174, 2, v180
    v_and_b32 v174, 7, v174
    v_lshrrev_b32 v173, 5, v180
    v_lshlrev_b32 v173, 12, v173
    v_lshlrev_b32 v183, 8, v174
    v_add_u32 v173, v173, v183
    s_lshl_b32 s26, s28, 2
    v_xor_b32 v174, s26, v174
    v_lshlrev_b32 v174, 5, v174
    v_add_u32 v173, v173, v174
    v_and_b32 v183, 3, v180
    v_lshlrev_b32 v183, 3, v183
    v_add_u32 v173, v173, v183
    v_add_u32 v173, 32768, v173
    v_xor_b32 v174, 32, v173
    v_xor_b32 v175, 64, v173
    v_xor_b32 v176, 96, v173
    v_lshrrev_b32 v184, 5, v180
    s_lshl_b32 s26, s28, 3
    v_add_u32 v184, s26, v184
    v_xor_b32 v184, v184, v182
    v_lshlrev_b32 v184, 4, v184
    v_lshlrev_b32 v183, 8, v182
    v_add_u32 v184, v184, v183
    v_and_b32 v183, 1, v181
    v_lshlrev_b32 v183, 3, v183
    v_add_u32 v184, v184, v183
    s_lshl_b32 s26, s27, 14
    s_add_u32 s26, s26, 98304
    v_add_u32 v184, s26, v184
    s_mov_b32 s12, s10
    s_and_b32 s13, s11, 0xffff
    s_mov_b32 s14, 8388608
    s_mov_b32 s15, 0x00020000
    v_lshrrev_b32 v181, 4, v180
    v_lshlrev_b32 v182, 4, v181
    v_xor_b32 v185, v182, v1
    s_lshl_b32 s27, s22, 12
    s_add_u32 s27, s27, 98304
    v_add_u32 v185, s27, v185
    v_lshlrev_b32 v186, 12, v181
    v_and_b32 v182, 0xf0, v1
    v_add_u32 v186, v186, v182
    s_lshl_b32 s47, s42, 3
    s_add_u32 s47, s47, s22
    s_lshl_b32 s47, s47, 16
    s_lshl_b32 s27, s41, 11
    s_add_u32 s47, s47, s27
    s_lshl_b32 s27, s43, 8
    s_add_u32 s47, s47, s27
    v_mov_b32 v8, s82
    v_mov_b32 v9, s82
    v_mov_b32 v10, s82
    v_mov_b32 v11, s82
    s_waitcnt vmcnt(0)
    s_barrier
    s_cmp_lg_u32 s22, 0
    s_cbranch_scc1 L_op_nopub
    s_mov_b64 exec, 0xff
    buffer_store_dwordx4 v[8:11], v1, s[16:19], s24 offen sc1
    s_mov_b64 exec, -1
L_op_nopub:
    s_cmp_lg_u32 s22, 1
    s_cbranch_scc1 L_op_ready
    s_mov_b32 s26, 0
L_op_poll:
    v_mov_b32 v181, s82
    s_mov_b64 exec, 0xffffffff
    v_mov_b32 v181, 0
    buffer_atomic_add v181, v187, s[16:19], s48 offen sc0 sc1
    s_mov_b64 exec, -1
    s_waitcnt vmcnt(0)
    v_cmp_ne_u32 s[34:35], s82, v181
    s_add_u32 s26, s26, 1
    s_nop 2
    s_cmp_eq_u64 s[34:35], 0
    s_cbranch_scc1 L_op_ready
    s_sleep 1
    s_cmp_lt_u32 s26, 0x200000
    s_cbranch_scc1 L_op_poll
L_op_ready:
    s_barrier
    s_barrier
    ds_read_b64_tr_b16 v[88:89], v173 offset:32768
    ds_read_b64_tr_b16 v[90:91], v173 offset:34816
    ds_read_b128 v[72:75], v172 offset:0
    ds_read_b128 v[76:79], v172 offset:256
    ds_read_b128 v[80:83], v172 offset:2048
    ds_read_b128 v[84:87], v172 offset:2304
    ds_read_b64_tr_b16 v[92:93], v174 offset:32768
    ds_read_b64_tr_b16 v[94:95], v174 offset:34816
    ds_read_b64_tr_b16 v[96:97], v175 offset:32768
    ds_read_b64_tr_b16 v[98:99], v175 offset:34816
    ds_read_b64_tr_b16 v[100:101], v176 offset:32768
    ds_read_b64_tr_b16 v[102:103], v176 offset:34816
    s_waitcnt lgkmcnt(0)
    s_barrier
    ds_read_b64_tr_b16 v[156:157], v173 offset:40960
    v_mfma_f32_16x16x32_bf16 v[8:11], v[88:91], v[72:75], 0
    ds_read_b64_tr_b16 v[158:159], v173 offset:43008
    v_mfma_f32_16x16x32_bf16 v[24:27], v[88:91], v[76:79], 0
    ds_read_b128 v[140:143], v172 offset:8192
    v_mfma_f32_16x16x32_bf16 v[40:43], v[88:91], v[80:83], 0
    ds_read_b128 v[144:147], v172 offset:8448
    v_mfma_f32_16x16x32_bf16 v[56:59], v[88:91], v[84:87], 0
    ds_read_b128 v[148:151], v172 offset:10240
    v_mfma_f32_16x16x32_bf16 v[60:63], v[92:95], v[84:87], 0
    ds_read_b128 v[152:155], v172 offset:10496
    v_mfma_f32_16x16x32_bf16 v[44:47], v[92:95], v[80:83], 0
    ds_read_b64_tr_b16 v[160:161], v174 offset:40960
    v_mfma_f32_16x16x32_bf16 v[28:31], v[92:95], v[76:79], 0
    ds_read_b64_tr_b16 v[162:163], v174 offset:43008
    v_mfma_f32_16x16x32_bf16 v[12:15], v[92:95], v[72:75], 0
    ds_read_b64_tr_b16 v[164:165], v175 offset:40960
    v_mfma_f32_16x16x32_bf16 v[16:19], v[96:99], v[72:75], 0
    ds_read_b64_tr_b16 v[166:167], v175 offset:43008
    v_mfma_f32_16x16x32_bf16 v[32:35], v[96:99], v[76:79], 0
    ds_read_b64_tr_b16 v[168:169], v176 offset:40960
    v_mfma_f32_16x16x32_bf16 v[48:51], v[96:99], v[80:83], 0
    ds_read_b64_tr_b16 v[170:171], v176 offset:43008
    v_mfma_f32_16x16x32_bf16 v[64:67], v[96:99], v[84:87], 0
    v_mfma_f32_16x16x32_bf16 v[68:71], v[100:103], v[84:87], 0
    v_mfma_f32_16x16x32_bf16 v[52:55], v[100:103], v[80:83], 0
    v_mfma_f32_16x16x32_bf16 v[36:39], v[100:103], v[76:79], 0
    v_mfma_f32_16x16x32_bf16 v[20:23], v[100:103], v[72:75], 0
    s_branch L_op_c2
.p2align 6
L_op_cloop:
    s_waitcnt lgkmcnt(0)
    s_barrier
    ds_read_b64_tr_b16 v[88:89], v173 offset:32768
    v_mfma_f32_16x16x32_bf16 v[8:11], v[156:159], v[140:143], v[8:11]
    ds_read_b64_tr_b16 v[90:91], v173 offset:34816
    v_mfma_f32_16x16x32_bf16 v[24:27], v[156:159], v[144:147], v[24:27]
    ds_read_b128 v[72:75], v172 offset:0
    v_mfma_f32_16x16x32_bf16 v[40:43], v[156:159], v[148:151], v[40:43]
    ds_read_b128 v[76:79], v172 offset:256
    v_mfma_f32_16x16x32_bf16 v[56:59], v[156:159], v[152:155], v[56:59]
    ds_read_b128 v[80:83], v172 offset:2048
    v_mfma_f32_16x16x32_bf16 v[60:63], v[160:163], v[152:155], v[60:63]
    ds_read_b128 v[84:87], v172 offset:2304
    v_mfma_f32_16x16x32_bf16 v[44:47], v[160:163], v[148:151], v[44:47]
    ds_read_b64_tr_b16 v[92:93], v174 offset:32768
    v_mfma_f32_16x16x32_bf16 v[28:31], v[160:163], v[144:147], v[28:31]
    ds_read_b64_tr_b16 v[94:95], v174 offset:34816
    v_mfma_f32_16x16x32_bf16 v[12:15], v[160:163], v[140:143], v[12:15]
    ds_read_b64_tr_b16 v[96:97], v175 offset:32768
    v_mfma_f32_16x16x32_bf16 v[16:19], v[164:167], v[140:143], v[16:19]
    ds_read_b64_tr_b16 v[98:99], v175 offset:34816
    v_mfma_f32_16x16x32_bf16 v[32:35], v[164:167], v[144:147], v[32:35]
    ds_read_b64_tr_b16 v[100:101], v176 offset:32768
    v_mfma_f32_16x16x32_bf16 v[48:51], v[164:167], v[148:151], v[48:51]
    ds_read_b64_tr_b16 v[102:103], v176 offset:34816
    v_mfma_f32_16x16x32_bf16 v[64:67], v[164:167], v[152:155], v[64:67]
    v_mfma_f32_16x16x32_bf16 v[68:71], v[168:171], v[152:155], v[68:71]
    v_mfma_f32_16x16x32_bf16 v[52:55], v[168:171], v[148:151], v[52:55]
    v_mfma_f32_16x16x32_bf16 v[36:39], v[168:171], v[144:147], v[36:39]
    v_mfma_f32_16x16x32_bf16 v[20:23], v[168:171], v[140:143], v[20:23]
    s_waitcnt lgkmcnt(0)
    s_barrier
    ds_read_b64_tr_b16 v[156:157], v173 offset:40960
    v_mfma_f32_16x16x32_bf16 v[8:11], v[88:91], v[72:75], v[8:11]
    ds_read_b64_tr_b16 v[158:159], v173 offset:43008
    v_mfma_f32_16x16x32_bf16 v[24:27], v[88:91], v[76:79], v[24:27]
    ds_read_b128 v[140:143], v172 offset:8192
    v_mfma_f32_16x16x32_bf16 v[40:43], v[88:91], v[80:83], v[40:43]
    ds_read_b128 v[144:147], v172 offset:8448
    v_mfma_f32_16x16x32_bf16 v[56:59], v[88:91], v[84:87], v[56:59]
    ds_read_b128 v[148:151], v172 offset:10240
    v_mfma_f32_16x16x32_bf16 v[60:63], v[92:95], v[84:87], v[60:63]
    ds_read_b128 v[152:155], v172 offset:10496
    v_mfma_f32_16x16x32_bf16 v[44:47], v[92:95], v[80:83], v[44:47]
    ds_read_b64_tr_b16 v[160:161], v174 offset:40960
    v_mfma_f32_16x16x32_bf16 v[28:31], v[92:95], v[76:79], v[28:31]
    ds_read_b64_tr_b16 v[162:163], v174 offset:43008
    v_mfma_f32_16x16x32_bf16 v[12:15], v[92:95], v[72:75], v[12:15]
    ds_read_b64_tr_b16 v[164:165], v175 offset:40960
    v_mfma_f32_16x16x32_bf16 v[16:19], v[96:99], v[72:75], v[16:19]
    ds_read_b64_tr_b16 v[166:167], v175 offset:43008
    v_mfma_f32_16x16x32_bf16 v[32:35], v[96:99], v[76:79], v[32:35]
    ds_read_b64_tr_b16 v[168:169], v176 offset:40960
    v_mfma_f32_16x16x32_bf16 v[48:51], v[96:99], v[80:83], v[48:51]
    ds_read_b64_tr_b16 v[170:171], v176 offset:43008
    v_mfma_f32_16x16x32_bf16 v[64:67], v[96:99], v[84:87], v[64:67]
    v_mfma_f32_16x16x32_bf16 v[68:71], v[100:103], v[84:87], v[68:71]
    v_mfma_f32_16x16x32_bf16 v[52:55], v[100:103], v[80:83], v[52:55]
    v_mfma_f32_16x16x32_bf16 v[36:39], v[100:103], v[76:79], v[36:39]
    v_mfma_f32_16x16x32_bf16 v[20:23], v[100:103], v[72:75], v[20:23]
L_op_c2:
    s_waitcnt lgkmcnt(0)
    s_barrier
    ds_read_b64_tr_b16 v[88:89], v173 offset:49152
    v_mfma_f32_16x16x32_bf16 v[8:11], v[156:159], v[140:143], v[8:11]
    ds_read_b64_tr_b16 v[90:91], v173 offset:51200
    v_mfma_f32_16x16x32_bf16 v[24:27], v[156:159], v[144:147], v[24:27]
    ds_read_b128 v[72:75], v172 offset:16384
    v_mfma_f32_16x16x32_bf16 v[40:43], v[156:159], v[148:151], v[40:43]
    ds_read_b128 v[76:79], v172 offset:16640
    v_mfma_f32_16x16x32_bf16 v[56:59], v[156:159], v[152:155], v[56:59]
    ds_read_b128 v[80:83], v172 offset:18432
    v_mfma_f32_16x16x32_bf16 v[60:63], v[160:163], v[152:155], v[60:63]
    ds_read_b128 v[84:87], v172 offset:18688
    v_mfma_f32_16x16x32_bf16 v[44:47], v[160:163], v[148:151], v[44:47]
    ds_read_b64_tr_b16 v[92:93], v174 offset:49152
    v_mfma_f32_16x16x32_bf16 v[28:31], v[160:163], v[144:147], v[28:31]
    ds_read_b64_tr_b16 v[94:95], v174 offset:51200
    v_mfma_f32_16x16x32_bf16 v[12:15], v[160:163], v[140:143], v[12:15]
    ds_read_b64_tr_b16 v[96:97], v175 offset:49152
    v_mfma_f32_16x16x32_bf16 v[16:19], v[164:167], v[140:143], v[16:19]
    ds_read_b64_tr_b16 v[98:99], v175 offset:51200
    v_mfma_f32_16x16x32_bf16 v[32:35], v[164:167], v[144:147], v[32:35]
    ds_read_b64_tr_b16 v[100:101], v176 offset:49152
    v_mfma_f32_16x16x32_bf16 v[48:51], v[164:167], v[148:151], v[48:51]
    ds_read_b64_tr_b16 v[102:103], v176 offset:51200
    v_mfma_f32_16x16x32_bf16 v[64:67], v[164:167], v[152:155], v[64:67]
    v_mfma_f32_16x16x32_bf16 v[68:71], v[168:171], v[152:155], v[68:71]
    v_mfma_f32_16x16x32_bf16 v[52:55], v[168:171], v[148:151], v[52:55]
    v_mfma_f32_16x16x32_bf16 v[36:39], v[168:171], v[144:147], v[36:39]
    v_mfma_f32_16x16x32_bf16 v[20:23], v[168:171], v[140:143], v[20:23]
    s_waitcnt lgkmcnt(0)
    s_barrier
    ds_read_b64_tr_b16 v[156:157], v173 offset:57344
    v_mfma_f32_16x16x32_bf16 v[8:11], v[88:91], v[72:75], v[8:11]
    ds_read_b64_tr_b16 v[158:159], v173 offset:59392
    v_mfma_f32_16x16x32_bf16 v[24:27], v[88:91], v[76:79], v[24:27]
    ds_read_b128 v[140:143], v172 offset:24576
    v_mfma_f32_16x16x32_bf16 v[40:43], v[88:91], v[80:83], v[40:43]
    ds_read_b128 v[144:147], v172 offset:24832
    v_mfma_f32_16x16x32_bf16 v[56:59], v[88:91], v[84:87], v[56:59]
    ds_read_b128 v[148:151], v172 offset:26624
    v_mfma_f32_16x16x32_bf16 v[60:63], v[92:95], v[84:87], v[60:63]
    ds_read_b128 v[152:155], v172 offset:26880
    v_mfma_f32_16x16x32_bf16 v[44:47], v[92:95], v[80:83], v[44:47]
    ds_read_b64_tr_b16 v[160:161], v174 offset:57344
    v_mfma_f32_16x16x32_bf16 v[28:31], v[92:95], v[76:79], v[28:31]
    ds_read_b64_tr_b16 v[162:163], v174 offset:59392
    v_mfma_f32_16x16x32_bf16 v[12:15], v[92:95], v[72:75], v[12:15]
    ds_read_b64_tr_b16 v[164:165], v175 offset:57344
    v_mfma_f32_16x16x32_bf16 v[16:19], v[96:99], v[72:75], v[16:19]
    ds_read_b64_tr_b16 v[166:167], v175 offset:59392
    v_mfma_f32_16x16x32_bf16 v[32:35], v[96:99], v[76:79], v[32:35]
    ds_read_b64_tr_b16 v[168:169], v176 offset:57344
    v_mfma_f32_16x16x32_bf16 v[48:51], v[96:99], v[80:83], v[48:51]
    ds_read_b64_tr_b16 v[170:171], v176 offset:59392
    v_mfma_f32_16x16x32_bf16 v[64:67], v[96:99], v[84:87], v[64:67]
    v_mfma_f32_16x16x32_bf16 v[68:71], v[100:103], v[84:87], v[68:71]
    v_mfma_f32_16x16x32_bf16 v[52:55], v[100:103], v[80:83], v[52:55]
    v_mfma_f32_16x16x32_bf16 v[36:39], v[100:103], v[76:79], v[36:39]
    v_mfma_f32_16x16x32_bf16 v[20:23], v[100:103], v[72:75], v[20:23]
    s_waitcnt lgkmcnt(0)
    s_barrier
    ds_read_b64_tr_b16 v[88:89], v173 offset:0
    v_mfma_f32_16x16x32_bf16 v[8:11], v[156:159], v[140:143], v[8:11]
    ds_read_b64_tr_b16 v[90:91], v173 offset:2048
    v_mfma_f32_16x16x32_bf16 v[24:27], v[156:159], v[144:147], v[24:27]
    ds_read_b128 v[72:75], v172 offset:0
    v_mfma_f32_16x16x32_bf16 v[40:43], v[156:159], v[148:151], v[40:43]
    ds_read_b128 v[76:79], v172 offset:256
    v_mfma_f32_16x16x32_bf16 v[56:59], v[156:159], v[152:155], v[56:59]
    ds_read_b128 v[80:83], v172 offset:2048
    v_mfma_f32_16x16x32_bf16 v[60:63], v[160:163], v[152:155], v[60:63]
    ds_read_b128 v[84:87], v172 offset:2304
    v_mfma_f32_16x16x32_bf16 v[44:47], v[160:163], v[148:151], v[44:47]
    ds_read_b64_tr_b16 v[92:93], v174 offset:0
    v_mfma_f32_16x16x32_bf16 v[28:31], v[160:163], v[144:147], v[28:31]
    ds_read_b64_tr_b16 v[94:95], v174 offset:2048
    v_mfma_f32_16x16x32_bf16 v[12:15], v[160:163], v[140:143], v[12:15]
    ds_read_b64_tr_b16 v[96:97], v175 offset:0
    v_mfma_f32_16x16x32_bf16 v[16:19], v[164:167], v[140:143], v[16:19]
    ds_read_b64_tr_b16 v[98:99], v175 offset:2048
    v_mfma_f32_16x16x32_bf16 v[32:35], v[164:167], v[144:147], v[32:35]
    ds_read_b64_tr_b16 v[100:101], v176 offset:0
    v_mfma_f32_16x16x32_bf16 v[48:51], v[164:167], v[148:151], v[48:51]
    ds_read_b64_tr_b16 v[102:103], v176 offset:2048
    v_mfma_f32_16x16x32_bf16 v[64:67], v[164:167], v[152:155], v[64:67]
    v_mfma_f32_16x16x32_bf16 v[68:71], v[168:171], v[152:155], v[68:71]
    v_mfma_f32_16x16x32_bf16 v[52:55], v[168:171], v[148:151], v[52:55]
    v_mfma_f32_16x16x32_bf16 v[36:39], v[168:171], v[144:147], v[36:39]
    v_mfma_f32_16x16x32_bf16 v[20:23], v[168:171], v[140:143], v[20:23]
    s_waitcnt lgkmcnt(0)
    s_barrier
    ds_read_b64_tr_b16 v[156:157], v173 offset:8192
    v_mfma_f32_16x16x32_bf16 v[8:11], v[88:91], v[72:75], v[8:11]
    ds_read_b64_tr_b16 v[158:159], v173 offset:10240
    v_mfma_f32_16x16x32_bf16 v[24:27], v[88:91], v[76:79], v[24:27]
    ds_read_b128 v[140:143], v172 offset:8192
    v_mfma_f32_16x16x32_bf16 v[40:43], v[88:91], v[80:83], v[40:43]
    ds_read_b128 v[144:147], v172 offset:8448
    v_mfma_f32_16x16x32_bf16 v[56:59], v[88:91], v[84:87], v[56:59]
    ds_read_b128 v[148:151], v172 offset:10240
    v_mfma_f32_16x16x32_bf16 v[60:63], v[92:95], v[84:87], v[60:63]
    ds_read_b128 v[152:155], v172 offset:10496
    v_mfma_f32_16x16x32_bf16 v[44:47], v[92:95], v[80:83], v[44:47]
    ds_read_b64_tr_b16 v[160:161], v174 offset:8192
    v_mfma_f32_16x16x32_bf16 v[28:31], v[92:95], v[76:79], v[28:31]
    ds_read_b64_tr_b16 v[162:163], v174 offset:10240
    v_mfma_f32_16x16x32_bf16 v[12:15], v[92:95], v[72:75], v[12:15]
    ds_read_b64_tr_b16 v[164:165], v175 offset:8192
    v_mfma_f32_16x16x32_bf16 v[16:19], v[96:99], v[72:75], v[16:19]
    ds_read_b64_tr_b16 v[166:167], v175 offset:10240
    v_mfma_f32_16x16x32_bf16 v[32:35], v[96:99], v[76:79], v[32:35]
    ds_read_b64_tr_b16 v[168:169], v176 offset:8192
    v_mfma_f32_16x16x32_bf16 v[48:51], v[96:99], v[80:83], v[48:51]
    ds_read_b64_tr_b16 v[170:171], v176 offset:10240
    v_mfma_f32_16x16x32_bf16 v[64:67], v[96:99], v[84:87], v[64:67]
    v_mfma_f32_16x16x32_bf16 v[68:71], v[100:103], v[84:87], v[68:71]
    v_mfma_f32_16x16x32_bf16 v[52:55], v[100:103], v[80:83], v[52:55]
    v_mfma_f32_16x16x32_bf16 v[36:39], v[100:103], v[76:79], v[36:39]
    v_mfma_f32_16x16x32_bf16 v[20:23], v[100:103], v[72:75], v[20:23]
    s_waitcnt lgkmcnt(0)
    s_barrier
    ds_read_b64_tr_b16 v[88:89], v173 offset:16384
    v_mfma_f32_16x16x32_bf16 v[8:11], v[156:159], v[140:143], v[8:11]
    ds_read_b64_tr_b16 v[90:91], v173 offset:18432
    v_mfma_f32_16x16x32_bf16 v[24:27], v[156:159], v[144:147], v[24:27]
    ds_read_b128 v[72:75], v172 offset:16384
    v_mfma_f32_16x16x32_bf16 v[40:43], v[156:159], v[148:151], v[40:43]
    ds_read_b128 v[76:79], v172 offset:16640
    v_mfma_f32_16x16x32_bf16 v[56:59], v[156:159], v[152:155], v[56:59]
    ds_read_b128 v[80:83], v172 offset:18432
    v_mfma_f32_16x16x32_bf16 v[60:63], v[160:163], v[152:155], v[60:63]
    ds_read_b128 v[84:87], v172 offset:18688
    v_mfma_f32_16x16x32_bf16 v[44:47], v[160:163], v[148:151], v[44:47]
    ds_read_b64_tr_b16 v[92:93], v174 offset:16384
    v_mfma_f32_16x16x32_bf16 v[28:31], v[160:163], v[144:147], v[28:31]
    ds_read_b64_tr_b16 v[94:95], v174 offset:18432
    v_mfma_f32_16x16x32_bf16 v[12:15], v[160:163], v[140:143], v[12:15]
    ds_read_b64_tr_b16 v[96:97], v175 offset:16384
    v_mfma_f32_16x16x32_bf16 v[16:19], v[164:167], v[140:143], v[16:19]
    ds_read_b64_tr_b16 v[98:99], v175 offset:18432
    v_mfma_f32_16x16x32_bf16 v[32:35], v[164:167], v[144:147], v[32:35]
    ds_read_b64_tr_b16 v[100:101], v176 offset:16384
    v_mfma_f32_16x16x32_bf16 v[48:51], v[164:167], v[148:151], v[48:51]
    ds_read_b64_tr_b16 v[102:103], v176 offset:18432
    v_mfma_f32_16x16x32_bf16 v[64:67], v[164:167], v[152:155], v[64:67]
    v_mfma_f32_16x16x32_bf16 v[68:71], v[168:171], v[152:155], v[68:71]
    v_mfma_f32_16x16x32_bf16 v[52:55], v[168:171], v[148:151], v[52:55]
    v_mfma_f32_16x16x32_bf16 v[36:39], v[168:171], v[144:147], v[36:39]
    v_mfma_f32_16x16x32_bf16 v[20:23], v[168:171], v[140:143], v[20:23]
    s_waitcnt lgkmcnt(0)
    s_barrier
    ds_read_b64_tr_b16 v[156:157], v173 offset:24576
    v_mfma_f32_16x16x32_bf16 v[8:11], v[88:91], v[72:75], v[8:11]
    ds_read_b64_tr_b16 v[158:159], v173 offset:26624
    v_mfma_f32_16x16x32_bf16 v[24:27], v[88:91], v[76:79], v[24:27]
    ds_read_b128 v[140:143], v172 offset:24576
    v_mfma_f32_16x16x32_bf16 v[40:43], v[88:91], v[80:83], v[40:43]
    ds_read_b128 v[144:147], v172 offset:24832
    v_mfma_f32_16x16x32_bf16 v[56:59], v[88:91], v[84:87], v[56:59]
    ds_read_b128 v[148:151], v172 offset:26624
    v_mfma_f32_16x16x32_bf16 v[60:63], v[92:95], v[84:87], v[60:63]
    ds_read_b128 v[152:155], v172 offset:26880
    v_mfma_f32_16x16x32_bf16 v[44:47], v[92:95], v[80:83], v[44:47]
    ds_read_b64_tr_b16 v[160:161], v174 offset:24576
    v_mfma_f32_16x16x32_bf16 v[28:31], v[92:95], v[76:79], v[28:31]
    ds_read_b64_tr_b16 v[162:163], v174 offset:26624
    v_mfma_f32_16x16x32_bf16 v[12:15], v[92:95], v[72:75], v[12:15]
    ds_read_b64_tr_b16 v[164:165], v175 offset:24576
    v_mfma_f32_16x16x32_bf16 v[16:19], v[96:99], v[72:75], v[16:19]
    ds_read_b64_tr_b16 v[166:167], v175 offset:26624
    v_mfma_f32_16x16x32_bf16 v[32:35], v[96:99], v[76:79], v[32:35]
    ds_read_b64_tr_b16 v[168:169], v176 offset:24576
    v_mfma_f32_16x16x32_bf16 v[48:51], v[96:99], v[80:83], v[48:51]
    ds_read_b64_tr_b16 v[170:171], v176 offset:26624
    v_mfma_f32_16x16x32_bf16 v[64:67], v[96:99], v[84:87], v[64:67]
    v_mfma_f32_16x16x32_bf16 v[68:71], v[100:103], v[84:87], v[68:71]
    v_mfma_f32_16x16x32_bf16 v[52:55], v[100:103], v[80:83], v[52:55]
    v_mfma_f32_16x16x32_bf16 v[36:39], v[100:103], v[76:79], v[36:39]
    v_mfma_f32_16x16x32_bf16 v[20:23], v[100:103], v[72:75], v[20:23]
    s_add_u32 s25, s25, 1
    s_cmp_lt_u32 s25, 4
    s_cbranch_scc1 L_op_cloop
    s_waitcnt lgkmcnt(0)
    v_mfma_f32_16x16x32_bf16 v[8:11], v[156:159], v[140:143], v[8:11]
    v_mfma_f32_16x16x32_bf16 v[24:27], v[156:159], v[144:147], v[24:27]
    v_mfma_f32_16x16x32_bf16 v[40:43], v[156:159], v[148:151], v[40:43]
    v_mfma_f32_16x16x32_bf16 v[56:59], v[156:159], v[152:155], v[56:59]
    v_mfma_f32_16x16x32_bf16 v[60:63], v[160:163], v[152:155], v[60:63]
    v_mfma_f32_16x16x32_bf16 v[44:47], v[160:163], v[148:151], v[44:47]
    v_mfma_f32_16x16x32_bf16 v[28:31], v[160:163], v[144:147], v[28:31]
    v_mfma_f32_16x16x32_bf16 v[12:15], v[160:163], v[140:143], v[12:15]
    v_mfma_f32_16x16x32_bf16 v[16:19], v[164:167], v[140:143], v[16:19]
    v_mfma_f32_16x16x32_bf16 v[32:35], v[164:167], v[144:147], v[32:35]
    v_mfma_f32_16x16x32_bf16 v[48:51], v[164:167], v[148:151], v[48:51]
    v_mfma_f32_16x16x32_bf16 v[64:67], v[164:167], v[152:155], v[64:67]
    v_mfma_f32_16x16x32_bf16 v[68:71], v[168:171], v[152:155], v[68:71]
    v_mfma_f32_16x16x32_bf16 v[52:55], v[168:171], v[148:151], v[52:55]
    v_mfma_f32_16x16x32_bf16 v[36:39], v[168:171], v[144:147], v[36:39]
    v_mfma_f32_16x16x32_bf16 v[20:23], v[168:171], v[140:143], v[20:23]
    s_nop 0
    v_cvt_pk_bf16_f32 v72, v8, v9
    v_cvt_pk_bf16_f32 v73, v10, v11
    ds_write_b64 v184, v[72:73] offset:0
    v_cvt_pk_bf16_f32 v74, v24, v25
    v_cvt_pk_bf16_f32 v75, v26, v27
    ds_write_b64 v184, v[74:75] offset:4096
    v_cvt_pk_bf16_f32 v76, v40, v41
    v_cvt_pk_bf16_f32 v77, v42, v43
    ds_write_b64 v184, v[76:77] offset:8192
    v_cvt_pk_bf16_f32 v78, v56, v57
    v_cvt_pk_bf16_f32 v79, v58, v59
    ds_write_b64 v184, v[78:79] offset:12288
    v_xor_b32 v181, 32, v184
    v_cvt_pk_bf16_f32 v80, v12, v13
    v_cvt_pk_bf16_f32 v81, v14, v15
    ds_write_b64 v181, v[80:81] offset:0
    v_cvt_pk_bf16_f32 v82, v28, v29
    v_cvt_pk_bf16_f32 v83, v30, v31
    ds_write_b64 v181, v[82:83] offset:4096
    v_cvt_pk_bf16_f32 v84, v44, v45
    v_cvt_pk_bf16_f32 v85, v46, v47
    ds_write_b64 v181, v[84:85] offset:8192
    v_cvt_pk_bf16_f32 v86, v60, v61
    v_cvt_pk_bf16_f32 v87, v62, v63
    ds_write_b64 v181, v[86:87] offset:12288
    v_xor_b32 v181, 64, v184
    v_cvt_pk_bf16_f32 v88, v16, v17
    v_cvt_pk_bf16_f32 v89, v18, v19
    ds_write_b64 v181, v[88:89] offset:0
    v_cvt_pk_bf16_f32 v90, v32, v33
    v_cvt_pk_bf16_f32 v91, v34, v35
    ds_write_b64 v181, v[90:91] offset:4096
    v_cvt_pk_bf16_f32 v92, v48, v49
    v_cvt_pk_bf16_f32 v93, v50, v51
    ds_write_b64 v181, v[92:93] offset:8192
    v_cvt_pk_bf16_f32 v94, v64, v65
    v_cvt_pk_bf16_f32 v95, v66, v67
    ds_write_b64 v181, v[94:95] offset:12288
    v_xor_b32 v181, 96, v184
    v_cvt_pk_bf16_f32 v96, v20, v21
    v_cvt_pk_bf16_f32 v97, v22, v23
    ds_write_b64 v181, v[96:97] offset:0
    v_cvt_pk_bf16_f32 v98, v36, v37
    v_cvt_pk_bf16_f32 v99, v38, v39
    ds_write_b64 v181, v[98:99] offset:4096
    v_cvt_pk_bf16_f32 v100, v52, v53
    v_cvt_pk_bf16_f32 v101, v54, v55
    ds_write_b64 v181, v[100:101] offset:8192
    v_cvt_pk_bf16_f32 v102, v68, v69
    v_cvt_pk_bf16_f32 v103, v70, v71
    ds_write_b64 v181, v[102:103] offset:12288
    s_waitcnt lgkmcnt(0)
L_op_store:
    s_barrier
    ds_read_b128 v[8:11], v185 offset:0
    v_xor_b32 v181, 64, v185
    ds_read_b128 v[12:15], v181 offset:1024
    v_xor_b32 v181, 128, v185
    ds_read_b128 v[16:19], v181 offset:2048
    v_xor_b32 v181, 192, v185
    ds_read_b128 v[20:23], v181 offset:3072
    s_waitcnt lgkmcnt(3)
    buffer_store_dwordx4 v[8:11], v186, s[12:15], s47 offen sc1
    s_add_u32 s47, s47, 16384
    s_waitcnt lgkmcnt(2)
    buffer_store_dwordx4 v[12:15], v186, s[12:15], s47 offen sc1
    s_add_u32 s47, s47, 16384
    s_waitcnt lgkmcnt(1)
    buffer_store_dwordx4 v[16:19], v186, s[12:15], s47 offen sc1
    s_add_u32 s47, s47, 16384
    s_waitcnt lgkmcnt(0)
    buffer_store_dwordx4 v[20:23], v186, s[12:15], s47 offen sc1
    s_lshl_b32 s26, s2, 3
    s_add_u32 s26, s26, s22
    s_cmp_lg_u32 s26, 2040
    s_cbranch_scc1 L_op_noep
    v_mov_b32 v24, s82
    v_mov_b32 v25, s82
    v_mov_b32 v26, s82
    v_mov_b32 v27, s82
    s_mov_b32 s26, 26869760
    s_mov_b64 exec, 0xff
    buffer_store_dwordx4 v[24:27], v1, s[16:19], s26 offen sc1
L_op_noep:
L_at_end:
    s_endpgm
L_at_first:
    s_waitcnt vmcnt(4)
    s_barrier
    s_cmp_ge_u32 s2, 128
    s_cbranch_scc1 L_at_first_ret
    buffer_store_dwordx4 v[196:199], v192, s[16:19], s86 offen offset:0 sc1
    buffer_store_dwordx4 v[200:203], v192, s[16:19], s86 offen offset:256 sc1
    buffer_store_dwordx4 v[204:207], v192, s[16:19], s86 offen offset:2048 sc1
    buffer_store_dwordx4 v[208:211], v192, s[16:19], s86 offen offset:2304 sc1
    s_branch L_at_first_ret
L_at_hook:
    s_cmp_eq_u32 s25, 0
    s_cbranch_scc1 L_at_h_pub
    s_cmp_eq_u32 s25, 1
    s_cbranch_scc1 L_at_h_poll
    s_cmp_lt_u32 s25, 4
    s_cbranch_scc1 L_at_h_load
    s_cmp_eq_u32 s25, 4
    s_cbranch_scc1 L_at_h_red
    s_cmp_eq_u32 s25, 7
    s_cbranch_scc1 L_at_h_wo
    ds_read_b128 v[180:183], v227
    ds_read_b128 v[184:187], v227 offset:1024
    ds_read_b128 v[188:191], v228
    ds_read_b128 v[192:195], v228 offset:32
    s_waitcnt lgkmcnt(0)
    v_mfma_f32_32x32x16_bf16 v[196:211], v[180:183], v[172:175], 0
    v_and_b32 v188, v230, v188
    v_and_b32 v189, v230, v189
    v_and_b32 v190, v230, v190
    v_and_b32 v191, v230, v191
    v_and_b32 v192, v230, v192
    v_and_b32 v193, v230, v193
    v_and_b32 v194, v230, v194
    v_and_b32 v195, v230, v195
    v_mfma_f32_32x32x16_bf16 v[196:211], v[184:187], v[176:179], v[196:211]
    s_nop 0
    v_mfma_f32_16x16x32_bf16 v[212:215], v[188:191], v[172:175], 0
    v_mfma_f32_16x16x32_bf16 v[212:215], v[192:195], v[176:179], v[212:215]
    s_nop 7
    v_add_f32 v212, 0x358637bd, v212
    v_rcp_f32 v212, v212
    s_nop 0
    v_mov_b32 v213, v212
    v_pk_mul_f32 v[196:197], v[196:197], v[212:213]
    v_pk_mul_f32 v[198:199], v[198:199], v[212:213]
    v_pk_mul_f32 v[200:201], v[200:201], v[212:213]
    v_pk_mul_f32 v[202:203], v[202:203], v[212:213]
    v_pk_mul_f32 v[204:205], v[204:205], v[212:213]
    v_pk_mul_f32 v[206:207], v[206:207], v[212:213]
    v_pk_mul_f32 v[208:209], v[208:209], v[212:213]
    v_pk_mul_f32 v[210:211], v[210:211], v[212:213]
    v_cvt_pk_bf16_f32 v180, v196, v197
    v_cvt_pk_bf16_f32 v181, v198, v199
    v_cvt_pk_bf16_f32 v182, v200, v201
    v_cvt_pk_bf16_f32 v183, v202, v203
    v_cvt_pk_bf16_f32 v184, v204, v205
    v_cvt_pk_bf16_f32 v185, v206, v207
    v_cvt_pk_bf16_f32 v186, v208, v209
    v_cvt_pk_bf16_f32 v187, v210, v211
    buffer_store_dwordx4 v[180:183], v1, s[16:19], s29 offen offset:0 sc1
    buffer_store_dwordx4 v[184:187], v1, s[16:19], s29 offen offset:1024 sc1
    s_branch L_at_hook_ret
L_at_h_load:
    s_load_dword s50, s[48:49], 0
    s_add_u32 m0, s40, 98304
    s_lshl_b32 s27, s20, 15
    s_add_u32 s27, s27, s40
    s_add_u32 s27, s27, 25165824
    buffer_load_dwordx4 v1, s[16:19], s27 offen offset:0 sc1 lds
    buffer_load_dwordx4 v1, s[16:19], s27 offen offset:1024 sc1 lds
    buffer_load_dwordx4 v1, s[16:19], s27 offen offset:2048 sc1 lds
    buffer_load_dwordx4 v1, s[16:19], s27 offen offset:3072 sc1 lds
    buffer_load_dwordx4 v[172:175], v1, s[16:19], s43 offen offset:0 sc1
    buffer_load_dwordx4 v[176:179], v1, s[16:19], s43 offen offset:1024 sc1
    s_cmp_lg_u32 s22, 0
    s_cbranch_scc1 L_at_hook_ret
    s_mov_b32 m0, 131072
    s_lshl_b32 s27, s20, 10
    s_add_u32 s27, s27, 26214400
    buffer_load_dwordx4 v1, s[16:19], s27 offen sc1 lds
    s_branch L_at_hook_ret
L_at_h_red:
    ds_read_b64 v[180:181], v218 offset:0
    ds_read_b64 v[182:183], v218 offset:4096
    ds_read_b64 v[184:185], v218 offset:8192
    ds_read_b64 v[186:187], v218 offset:12288
    ds_read_b64 v[188:189], v218 offset:16384
    ds_read_b64 v[190:191], v218 offset:20480
    ds_read_b64 v[192:193], v218 offset:24576
    ds_read_b64 v[194:195], v218 offset:28672
    s_waitcnt lgkmcnt(0)
    v_pk_add_f32 v[180:181], v[180:181], v[182:183]
    v_pk_add_f32 v[184:185], v[184:185], v[186:187]
    v_pk_add_f32 v[188:189], v[188:189], v[190:191]
    v_pk_add_f32 v[192:193], v[192:193], v[194:195]
    v_pk_add_f32 v[180:181], v[180:181], v[184:185]
    v_pk_add_f32 v[188:189], v[188:189], v[192:193]
    v_pk_add_f32 v[180:181], v[180:181], v[188:189]
    v_cvt_pk_bf16_f32 v180, v180, v181
    ds_write_b32 v221, v180
    s_cmp_lg_u32 s22, 0
    s_cbranch_scc1 L_at_hook_ret
    ds_read_b64 v[196:197], v219 offset:0
    ds_read_b64 v[198:199], v219 offset:128
    ds_read_b64 v[200:201], v219 offset:256
    ds_read_b64 v[202:203], v219 offset:384
    ds_read_b64 v[204:205], v219 offset:512
    ds_read_b64 v[206:207], v219 offset:640
    ds_read_b64 v[208:209], v219 offset:768
    ds_read_b64 v[210:211], v219 offset:896
    s_waitcnt lgkmcnt(0)
    v_pk_add_f32 v[196:197], v[196:197], v[198:199]
    v_pk_add_f32 v[200:201], v[200:201], v[202:203]
    v_pk_add_f32 v[204:205], v[204:205], v[206:207]
    v_pk_add_f32 v[208:209], v[208:209], v[210:211]
    v_pk_add_f32 v[196:197], v[196:197], v[200:201]
    v_pk_add_f32 v[204:205], v[204:205], v[208:209]
    v_pk_add_f32 v[196:197], v[196:197], v[204:205]
    v_cvt_pk_bf16_f32 v196, v196, v197
    ds_write_b32 v222, v196
    s_branch L_at_hook_ret
L_at_h_wo:
    s_lshl_b32 s27, s32, 17
    s_add_u32 s26, s51, s27
    s_and_b32 s27, s22, 3
    s_lshl_b32 s27, s27, 11
    s_lshl_b32 s28, s32, 14
    s_add_u32 s27, s27, s28
    s_add_u32 m0, s27, 65536
    s_nop 0
    buffer_load_dwordx4 v231, s[36:39], s26 offen lds
    buffer_load_dwordx4 v232, s[36:39], s26 offen offset:1024 lds
    s_add_u32 s26, s26, 65536
    s_add_u32 m0, s27, 73728
    s_nop 0
    buffer_load_dwordx4 v231, s[36:39], s26 offen lds
    buffer_load_dwordx4 v232, s[36:39], s26 offen offset:1024 lds
    s_add_u32 s26, s26, 65536
    s_cmp_lg_u32 s22, 0
    s_cbranch_scc1 L_at_hook_ret
    v_mov_b32 v212, s82
    v_mov_b32 v213, s82
    v_mov_b32 v214, s82
    v_mov_b32 v215, s82
    s_mov_b64 exec, 0xff
    buffer_store_dwordx4 v[212:215], v1, s[16:19], s24 offen sc1
    s_mov_b64 exec, -1
    s_branch L_at_hook_ret
L_at_h_pub:
    s_cmp_ge_u32 s2, 128
    s_cbranch_scc1 L_at_hook_ret
    s_mov_b64 exec, 0xff
    buffer_store_dwordx4 v[212:215], v1, s[16:19], s83 offen sc1
    s_mov_b64 exec, -1
    s_branch L_at_hook_ret
L_at_h_poll:
    s_mov_b32 s26, 0
L_at_h_poll2:
    v_mov_b32 v216, s82
    s_mov_b64 exec, 0xff
    v_mov_b32 v216, 0
    buffer_atomic_add v216, v233, s[16:19], s52 offen sc0 sc1
    s_mov_b64 exec, -1
    s_waitcnt vmcnt(0)
    v_cmp_ne_u32 s[34:35], s82, v216
    s_add_u32 s26, s26, 1
    s_nop 2
    s_cmp_eq_u64 s[34:35], 0
    s_cbranch_scc1 L_at_hook_ret
    s_sleep 1
    s_cmp_lt_u32 s26, 0x200000
    s_cbranch_scc1 L_at_h_poll2
    s_branch L_at_hook_ret
L_at_fallback:
    s_waitcnt vmcnt(0) lgkmcnt(0)
    s_mov_b32 s31, 1
    s_mov_b32 s44, 128
    s_mov_b32 s45, 99
    s_mov_b32 s23, 0
    s_mov_b32 s14, 262144
    s_mov_b32 m0, s40
    s_nop 0
    buffer_load_dwordx4 v2, s[12:15], s23 offen offset:0 sc1 lds
    buffer_load_dwordx4 v2, s[12:15], s23 offen offset:1024 sc1 lds
    buffer_load_dwordx4 v2, s[12:15], s23 offen offset:2048 sc1 lds
    buffer_load_dwordx4 v2, s[12:15], s23 offen offset:3072 sc1 lds
    s_mov_b32 s23, 16384
    v_mov_b32 v24, 0xff800000
    v_mov_b32 v40, 0xff800000
    s_mov_b32 s26, 0
L_at_maxloop:
    buffer_load_dwordx4 v[140:143], v1, s[12:15], s26 offen sc1
    buffer_load_dwordx4 v[144:147], v1, s[12:15], s26 offen offset:1024 sc1
    s_waitcnt vmcnt(0)
    v_mfma_f32_32x32x16_bf16 v[56:71], v[140:143], v[8:11], 0
    v_mfma_f32_32x32x16_bf16 v[72:87], v[140:143], v[16:19], 0
    v_mfma_f32_32x32x16_bf16 v[56:71], v[144:147], v[12:15], v[56:71]
    v_mfma_f32_32x32x16_bf16 v[72:87], v[144:147], v[20:23], v[72:87]
    s_nop 7
    s_nop 7
    v_max3_f32 v24, v24, v56, v57
    v_max3_f32 v24, v24, v58, v59
    v_max3_f32 v24, v24, v60, v61
    v_max3_f32 v24, v24, v62, v63
    v_max3_f32 v24, v24, v64, v65
    v_max3_f32 v24, v24, v66, v67
    v_max3_f32 v24, v24, v68, v69
    v_max3_f32 v24, v24, v70, v71
    v_max3_f32 v40, v40, v72, v73
    v_max3_f32 v40, v40, v74, v75
    v_max3_f32 v40, v40, v76, v77
    v_max3_f32 v40, v40, v78, v79
    v_max3_f32 v40, v40, v80, v81
    v_max3_f32 v40, v40, v82, v83
    v_max3_f32 v40, v40, v84, v85
    v_max3_f32 v40, v40, v86, v87
    s_add_u32 s26, s26, 4096
    s_cmp_lt_u32 s26, 262144
    s_cbranch_scc1 L_at_maxloop
    v_mov_b32 v25, v24
    s_nop 1
    v_permlane32_swap_b32 v24, v25
    v_max_f32 v24, v24, v25
    v_sub_f32 v24, 0, v24
    v_mov_b32 v25, v24
    v_mov_b32 v26, v24
    v_mov_b32 v27, v24
    v_mov_b32 v28, v24
    v_mov_b32 v29, v24
    v_mov_b32 v30, v24
    v_mov_b32 v31, v24
    v_mov_b32 v32, v24
    v_mov_b32 v33, v24
    v_mov_b32 v34, v24
    v_mov_b32 v35, v24
    v_mov_b32 v36, v24
    v_mov_b32 v37, v24
    v_mov_b32 v38, v24
    v_mov_b32 v39, v24
    v_mov_b32 v41, v40
    s_nop 1
    v_permlane32_swap_b32 v40, v41
    v_max_f32 v40, v40, v41
    v_sub_f32 v40, 0, v40
    v_mov_b32 v41, v40
    v_mov_b32 v42, v40
    v_mov_b32 v43, v40
    v_mov_b32 v44, v40
    v_mov_b32 v45, v40
    v_mov_b32 v46, v40
    v_mov_b32 v47, v40
    v_mov_b32 v48, v40
    v_mov_b32 v49, v40
    v_mov_b32 v50, v40
    v_mov_b32 v51, v40
    v_mov_b32 v52, v40
    v_mov_b32 v53, v40
    v_mov_b32 v54, v40
    v_mov_b32 v55, v40
    v_mov_b32 v88, 0
    v_mov_b32 v89, 0
    v_mov_b32 v90, 0
    v_mov_b32 v91, 0
    v_mov_b32 v92, 0
    v_mov_b32 v93, 0
    v_mov_b32 v94, 0
    v_mov_b32 v95, 0
    v_mov_b32 v96, 0
    v_mov_b32 v97, 0
    v_mov_b32 v98, 0
    v_mov_b32 v99, 0
    v_mov_b32 v100, 0
    v_mov_b32 v101, 0
    v_mov_b32 v102, 0
    v_mov_b32 v103, 0
    v_mov_b32 v120, 0
    v_mov_b32 v121, 0
    v_mov_b32 v122, 0
    v_mov_b32 v123, 0
    v_mov_b32 v104, 0
    v_mov_b32 v105, 0
    v_mov_b32 v106, 0
    v_mov_b32 v107, 0
    v_mov_b32 v108, 0
    v_mov_b32 v109, 0
    v_mov_b32 v110, 0
    v_mov_b32 v111, 0
    v_mov_b32 v112, 0
    v_mov_b32 v113, 0
    v_mov_b32 v114, 0
    v_mov_b32 v115, 0
    v_mov_b32 v116, 0
    v_mov_b32 v117, 0
    v_mov_b32 v118, 0
    v_mov_b32 v119, 0
    v_mov_b32 v124, 0
    v_mov_b32 v125, 0
    v_mov_b32 v126, 0
    v_mov_b32 v127, 0
    v_mov_b32 v132, 0
    v_mov_b32 v133, 0
    v_mov_b32 v134, 0
    v_mov_b32 v135, 0
    v_mov_b32 v4, v217
    v_add_u32 v5, 32768, v217
    s_mov_b32 s33, 32768
    s_mov_b32 s25, 0
    s_barrier
    ds_read_b128 v[140:143], v217
    ds_read_b128 v[144:147], v217 offset:1024
    ds_read_b128 v[148:151], v217 offset:4096
    ds_read_b128 v[152:155], v217 offset:5120
    ds_read_b128 v[156:159], v217 offset:2048
    ds_read_b128 v[160:163], v217 offset:3072
    s_branch L_at_go
L_at_code_end:
.section .rodata,"a"
.p2align 6
.amdhsa_kernel concat_heads__linear_attn_block__softmax_full_mha__prompt_kernel
  .amdhsa_next_free_vgpr 256
  .amdhsa_next_free_sgpr 88
  .amdhsa_accum_offset 256
  .amdhsa_group_segment_fixed_size 0
  .amdhsa_kernarg_size 72
  .amdhsa_user_sgpr_count 2
  .amdhsa_user_sgpr_kernarg_segment_ptr 1
  .amdhsa_system_sgpr_workgroup_id_x 1
  .amdhsa_float_denorm_mode_32 3
  .amdhsa_float_denorm_mode_16_64 3
.end_amdhsa_kernel
```
